```python
import torch

def _softmax(x, axis=-1):
    return torch.softmax(x, dim=axis)
def _gelu(x):
    return torch.nn.functional.gelu(x, approximate="tanh")
def _silu(x):
    return torch.nn.functional.silu(x)
def _sigmoid(x):
    return torch.sigmoid(x)
def _layernorm(x, axis=-1, eps=1e-5):
    m = x.mean(dim=axis, keepdim=True)
    v = x.var(dim=axis, keepdim=True, unbiased=False)
    return (x - m) / torch.sqrt(v + eps)
def _scatter_add(tgt, idx, src, axis=0):
    return tgt.clone().index_add_(axis, idx, src)
def _segment_sum(src, seg, n):
    out = torch.zeros((n,) + src.shape[1:], dtype=src.dtype)
    return out.index_add_(0, seg, src)
def _pad(x, pw):
    flat = tuple(v for pair in reversed(pw) for v in pair)
    return torch.nn.functional.pad(x, flat)

kernel_name = 'sequential_preLN__sliding_local_dilated__dense_activation_silu__prompt'

def setup_inputs():

    _w = (lambda a: (lambda t: t.to(torch.bfloat16) if t.is_floating_point() else t)(torch.as_tensor(a)))
    def _A_setup():
        B, S, D = 1, 2048, 512
        return {
            "x": _w((lambda *s: torch.randn(*s, dtype=torch.bfloat16) * 0.05)(B, S, D)),
            "wqkv": _w((lambda *s: torch.randn(*s, dtype=torch.bfloat16) * 0.05)(D, 3 * D)),
            "wo": _w((lambda *s: torch.randn(*s, dtype=torch.bfloat16) * 0.05)(D, D)),
        }
    _A_in = _A_setup()

    def _B_setup():
        B, S, D, F = 1, 2048, 512, 1792
        return {
            "x": _w((lambda *s: torch.randn(*s, dtype=torch.bfloat16) * 0.05)(B, S, D)),
            "w1": _w((lambda *s: torch.randn(*s, dtype=torch.bfloat16) * 0.8)(D, F) * (D ** -0.5)),
            "w2": _w((lambda *s: torch.randn(*s, dtype=torch.bfloat16) * 0.8)(F, D) * (F ** -0.5)),
        }
    _B_in = _B_setup()

    return {
        "A_x": _A_in["x"],
        "A_wqkv": _A_in["wqkv"],
        "A_wo": _A_in["wo"],
        "B_x": _B_in["x"],
        "B_w1": _B_in["w1"],
        "B_w2": _B_in["w2"],
    }

def reference(A_x, A_wqkv, A_wo, B_x, B_w1, B_w2):
    def _A_ref(x, wqkv, wo):
        B, S, D = x.shape
        H = 32; Dh = D // H
        W, dil = 8, 2
        qkv = (lambda x, *d: x.permute(*d))((x @ wqkv).reshape(B, S, 3, H, Dh), 2, 0, 3, 1, 4)
        q, k, v = qkv[0], qkv[1], qkv[2]
        scale = Dh ** -0.5
        pos = torch.arange(S)
        off = torch.arange(W) * dil
        idx = pos[:, None] - off[None, :]
        mask = idx >= 0
        idx_c = torch.where(mask, idx, 0).reshape(-1)
        kg = k[:, :, idx_c, :].reshape(B, H, S, W, Dh)
        vg = v[:, :, idx_c, :].reshape(B, H, S, W, Dh)
        logits = torch.einsum("bhsd,bhswd->bhsw", q, kg) * scale
        logits = torch.where(mask[None, None, :, :], logits, -1e9)
        attn = _softmax(logits, axis=-1)
        o = torch.einsum("bhsw,bhswd->bhsd", attn, vg)
        return (lambda x, *d: x.permute(*d))(o, 0, 2, 1, 3).reshape(B, S, D) @ wo

    def _B_ref(x, w1, w2):
        h = torch.einsum("bsd,df->bsf", x, w1)
        h = _silu(h)
        out = torch.einsum("bsf,fd->bsd", h, w2)
        return out

    x = A_x
    h = x + _A_ref(_layernorm(x, axis=-1), A_wqkv, A_wo)
    h2 = h + _B_ref(_layernorm(h, axis=-1), B_w1, B_w2)
    return h2
```

```asm
; @launch grid=(256,1,1) block=(512,1,1) lds=163840
.amdgcn_target "amdgcn-amd-amdhsa--gfx950"
.text
.globl sequential_preLN__sliding_local_dilated__dense_activation_silu__prompt_kernel
.p2align 8
.type sequential_preLN__sliding_local_dilated__dense_activation_silu__prompt_kernel,@function
sequential_preLN__sliding_local_dilated__dense_activation_silu__prompt_kernel:
  s_cmp_ge_u32 s2, 256
  s_cbranch_scc1 L_end
  s_load_dwordx16 s[84:99], s[0:1], 0
  s_load_dwordx2 s[100:101], s[0:1], 64
  s_getpc_b64 s[4:5]
L_pc:
  v_and_b32 v1, 63, v0
  v_lshrrev_b32 v9, 6, v0
  s_and_b32 s40, s2, 31
  v_readfirstlane_b32 s6, v9
  s_lshr_b32 s41, s2, 5
  v_and_b32 v2, 15, v1
  v_lshrrev_b32 v3, 4, v1
  s_lshl_b32 s52, s40, 16
  s_lshl_b32 s53, s40, 16
  s_lshl_b32 s3, s40, 18
  s_and_b32 s42, s6, 3
  v_lshlrev_b32 v4, 4, v1
  v_mov_b32 v8, 162816
  s_cmp_ge_u32 s6, 4
  s_cbranch_scc1 L_loader
  s_setprio 3
  v_and_b32 v9, 7, v2
  v_xor_b32 v10, v3, v9
  v_lshlrev_b32 v10, 4, v10
  v_lshl_add_u32 v10, v9, 7, v10
  v_lshrrev_b32 v9, 3, v2
  v_lshl_add_u32 v14, v9, 10, v10
  v_xor_b32 v15, 64, v14
  s_lshl_b32 s48, s42, 11
  s_add_u32 s48, s48, 2048
  v_add_u32 v16, s48, v14
  v_add_u32 v17, s48, v15
  v_lshrrev_b32 v9, 2, v2
  v_and_b32 v10, 3, v1
  v_lshrrev_b32 v11, 1, v10
  s_lshl_b32 s48, s42, 1
  v_add_u32 v11, s48, v11
  v_lshrrev_b32 v12, 1, v9
  v_lshlrev_b32 v12, 1, v12
  v_xor_b32 v11, v11, v12
  v_and_b32 v12, 1, v3
  v_lshlrev_b32 v12, 2, v12
  v_xor_b32 v11, v11, v12
  v_lshlrev_b32 v11, 4, v11
  v_lshl_add_u32 v11, v9, 7, v11
  v_and_b32 v12, 1, v10
  v_lshl_add_u32 v11, v12, 3, v11
  s_movk_i32 s49, 3072
  v_mul_lo_u32 v12, v3, s49
  v_add_u32 v18, v11, v12
  s_lshl_b32 s48, s42, 12
  v_lshlrev_b32 v11, 4, v10
  v_lshl_add_u32 v11, v9, 6, v11
  v_lshl_add_u32 v11, v3, 9, v11
  v_add_u32 v7, s48, v11
  v_lshrrev_b32 v11, 1, v9
  v_lshlrev_b32 v11, 2, v11
  v_xor_b32 v11, v10, v11
  v_lshlrev_b32 v11, 4, v11
  v_lshl_add_u32 v11, v9, 7, v11
  v_lshl_add_u32 v11, v3, 10, v11
  v_add_u32 v5, s48, v11
  v_xor_b32 v6, 64, v5
  v_mov_b32 v48, 0
  v_mov_b32 v49, 0
  v_mov_b32 v50, 0
  v_mov_b32 v51, 0
  v_mov_b32 v52, 0
  v_mov_b32 v53, 0
  v_mov_b32 v54, 0
  v_mov_b32 v55, 0
  v_mov_b32 v56, 0
  v_mov_b32 v57, 0
  v_mov_b32 v58, 0
  v_mov_b32 v59, 0
  v_mov_b32 v60, 0
  v_mov_b32 v61, 0
  v_mov_b32 v62, 0
  v_mov_b32 v63, 0
  v_mov_b32 v64, 0
  v_mov_b32 v65, 0
  v_mov_b32 v66, 0
  v_mov_b32 v67, 0
  v_mov_b32 v68, 0
  v_mov_b32 v69, 0
  v_mov_b32 v70, 0
  v_mov_b32 v71, 0
  v_mov_b32 v72, 0
  v_mov_b32 v73, 0
  v_mov_b32 v74, 0
  v_mov_b32 v75, 0
  v_mov_b32 v76, 0
  v_mov_b32 v77, 0
  v_mov_b32 v78, 0
  v_mov_b32 v79, 0
  v_mov_b32 v80, 0
  v_mov_b32 v81, 0
  v_mov_b32 v82, 0
  v_mov_b32 v83, 0
  v_mov_b32 v84, 0
  v_mov_b32 v85, 0
  v_mov_b32 v86, 0
  v_mov_b32 v87, 0
  v_mov_b32 v88, 0
  v_mov_b32 v89, 0
  v_mov_b32 v90, 0
  v_mov_b32 v91, 0
  v_mov_b32 v92, 0
  v_mov_b32 v93, 0
  v_mov_b32 v94, 0
  v_mov_b32 v95, 0
  v_mov_b32 v96, 0
  v_mov_b32 v97, 0
  v_mov_b32 v98, 0
  v_mov_b32 v99, 0
  v_mov_b32 v100, 0
  v_mov_b32 v101, 0
  v_mov_b32 v102, 0
  v_mov_b32 v103, 0
  v_mov_b32 v104, 0
  v_mov_b32 v105, 0
  v_mov_b32 v106, 0
  v_mov_b32 v107, 0
  v_mov_b32 v108, 0
  v_mov_b32 v109, 0
  v_mov_b32 v110, 0
  v_mov_b32 v111, 0
  v_mov_b32 v112, 0
  v_mov_b32 v113, 0
  v_mov_b32 v114, 0
  v_mov_b32 v115, 0
  v_mov_b32 v116, 0
  v_mov_b32 v117, 0
  v_mov_b32 v118, 0
  v_mov_b32 v119, 0
  v_mov_b32 v120, 0x3f803f80
  v_mov_b32 v121, 0x3f803f80
  v_mov_b32 v122, 0x3f803f80
  v_mov_b32 v123, 0x3f803f80
  v_lshlrev_b32 v9, 2, v3
  v_sub_u32 v9, v2, v9
  v_and_b32 v10, 1, v2
  v_cmp_eq_u32 s[74:75], 1, v10
  v_sub_u32 v9, v9, v10
  v_cmp_le_i32 s[54:55], 0, v9
  v_cmp_gt_i32 s[58:59], 0, v9
  v_subrev_u32 v9, 2, v9
  v_cmp_le_i32 s[56:57], 0, v9
  v_cmp_gt_i32 s[60:61], 0, v9
  v_lshrrev_b32 v10, 2, v2
  v_cmp_eq_u32 s[66:67], v10, v3
  v_and_b32 v10, 3, v1
  v_cmp_eq_u32 s[68:69], 1, v10
  v_cmp_eq_u32 s[70:71], 2, v10
  v_cmp_eq_u32 s[72:73], 3, v10
  s_cmp_eq_u32 s40, 0
  s_cselect_b64 s[62:63], 0, s[58:59]
  s_cselect_b64 s[64:65], 0, s[60:61]
  s_lshl_b32 s76, s41, 2
  s_add_u32 s76, s76, s42
  s_lshl_b32 s76, s76, 2
  s_lshl_b32 s48, s40, 9
  s_add_u32 s76, s76, s48
  s_waitcnt lgkmcnt(0)
  s_mov_b32 s8, s84
  s_and_b32 s9, s85, 0xffff
  s_mov_b32 s10, 2097152
  s_mov_b32 s11, 0x20000
  s_mov_b32 s28, s96
  s_and_b32 s29, s97, 0xffff
  s_mov_b32 s30, 2097152
  s_mov_b32 s31, 0x20000
  s_mov_b32 s36, s100
  s_and_b32 s37, s101, 0xffff
  s_mov_b32 s38, 268435456
  s_mov_b32 s39, 0x20000
  s_mov_b32 s84, 0
  s_lshl_b32 s50, s42, 2
  s_add_u32 s50, s50, 162816
  v_mov_b32 v126, s50
  s_mov_b32 s101, 0
  s_barrier
  s_mov_b32 s45, 81920
  v_add_u32 v19, s45, v18
  ds_read_b64_tr_b16 a[48:49], v19 offset:0
  ds_read_b64_tr_b16 a[50:51], v19 offset:512
  ds_read_b64_tr_b16 a[52:53], v19 offset:1024
  ds_read_b64_tr_b16 a[54:55], v19 offset:1536
  ds_read_b64_tr_b16 a[56:57], v19 offset:2048
  ds_read_b64_tr_b16 a[58:59], v19 offset:2560
  ds_read_b128 a[0:3], v14 offset:0
  ds_read_b128 a[4:7], v14 offset:2048
  ds_read_b128 a[8:11], v14 offset:4096
  ds_read_b128 a[12:15], v14 offset:6144
  ds_read_b128 a[16:19], v14 offset:8192
  ds_read_b128 a[20:23], v16 offset:0
  s_mov_b32 s44, 0
L_k1loop:
  s_waitcnt lgkmcnt(0)
  v_mfma_f32_16x16x32_bf16 v[48:51], a[48:51], a[0:3], v[48:51]
  ds_read_b64_tr_b16 a[60:61], v19 offset:12288
  v_mfma_f32_16x16x32_bf16 v[68:71], a[52:55], a[0:3], v[68:71]
  ds_read_b64_tr_b16 a[62:63], v19 offset:12800
  v_mfma_f32_16x16x32_bf16 v[88:91], a[0:3], a[56:59], v[88:91]
  ds_read_b64_tr_b16 a[64:65], v19 offset:13312
  v_mfma_f32_16x16x32_bf16 v[52:55], a[48:51], a[4:7], v[52:55]
  ds_read_b64_tr_b16 a[66:67], v19 offset:13824
  v_mfma_f32_16x16x32_bf16 v[72:75], a[52:55], a[4:7], v[72:75]
  ds_read_b64_tr_b16 a[68:69], v19 offset:14336
  v_mfma_f32_16x16x32_bf16 v[92:95], a[4:7], a[56:59], v[92:95]
  ds_read_b64_tr_b16 a[70:71], v19 offset:14848
  v_mfma_f32_16x16x32_bf16 v[56:59], a[48:51], a[8:11], v[56:59]
  ds_read_b128 a[24:27], v15 offset:0
  v_mfma_f32_16x16x32_bf16 v[76:79], a[52:55], a[8:11], v[76:79]
  ds_read_b128 a[28:31], v15 offset:2048
  v_mfma_f32_16x16x32_bf16 v[96:99], a[8:11], a[56:59], v[96:99]
  ds_read_b128 a[32:35], v15 offset:4096
  v_mfma_f32_16x16x32_bf16 v[60:63], a[48:51], a[12:15], v[60:63]
  ds_read_b128 a[36:39], v15 offset:6144
  v_mfma_f32_16x16x32_bf16 v[80:83], a[52:55], a[12:15], v[80:83]
  ds_read_b128 a[40:43], v15 offset:8192
  v_mfma_f32_16x16x32_bf16 v[100:103], a[12:15], a[56:59], v[100:103]
  ds_read_b128 a[44:47], v17 offset:0
  v_mfma_f32_16x16x32_bf16 v[64:67], a[48:51], a[16:19], v[64:67]
  s_add_u32 s45, s45, 24576
  v_mfma_f32_16x16x32_bf16 v[84:87], a[52:55], a[16:19], v[84:87]
  s_cmp_eq_u32 s45, 155648
  v_mfma_f32_16x16x32_bf16 v[104:107], a[16:19], a[56:59], v[104:107]
  s_cselect_b32 s45, 81920, s45
  v_mfma_f32_16x16x32_bf16 v[116:119], a[0:3], a[0:3], v[116:119]
  v_add_u32 v14, 10240, v14
  v_mfma_f32_16x16x32_bf16 v[108:111], v[120:123], a[20:23], v[108:111]
  v_add_u32 v16, 10240, v16
  v_mfma_f32_16x16x32_bf16 v[112:115], a[20:23], a[20:23], v[112:115]
  s_waitcnt lgkmcnt(0)
  s_barrier
  v_add_u32 v19, s45, v18
  v_mfma_f32_16x16x32_bf16 v[48:51], a[60:63], a[24:27], v[48:51]
  ds_read_b64_tr_b16 a[48:49], v19 offset:0
  v_mfma_f32_16x16x32_bf16 v[68:71], a[64:67], a[24:27], v[68:71]
  ds_read_b64_tr_b16 a[50:51], v19 offset:512
  v_mfma_f32_16x16x32_bf16 v[88:91], a[24:27], a[68:71], v[88:91]
  ds_read_b64_tr_b16 a[52:53], v19 offset:1024
  v_mfma_f32_16x16x32_bf16 v[52:55], a[60:63], a[28:31], v[52:55]
  ds_read_b64_tr_b16 a[54:55], v19 offset:1536
  v_mfma_f32_16x16x32_bf16 v[72:75], a[64:67], a[28:31], v[72:75]
  ds_read_b64_tr_b16 a[56:57], v19 offset:2048
  v_mfma_f32_16x16x32_bf16 v[92:95], a[28:31], a[68:71], v[92:95]
  ds_read_b64_tr_b16 a[58:59], v19 offset:2560
  v_mfma_f32_16x16x32_bf16 v[56:59], a[60:63], a[32:35], v[56:59]
  ds_read_b128 a[0:3], v14 offset:0
  v_mfma_f32_16x16x32_bf16 v[76:79], a[64:67], a[32:35], v[76:79]
  ds_read_b128 a[4:7], v14 offset:2048
  v_mfma_f32_16x16x32_bf16 v[96:99], a[32:35], a[68:71], v[96:99]
  ds_read_b128 a[8:11], v14 offset:4096
  v_mfma_f32_16x16x32_bf16 v[60:63], a[60:63], a[36:39], v[60:63]
  ds_read_b128 a[12:15], v14 offset:6144
  v_mfma_f32_16x16x32_bf16 v[80:83], a[64:67], a[36:39], v[80:83]
  ds_read_b128 a[16:19], v14 offset:8192
  v_mfma_f32_16x16x32_bf16 v[100:103], a[36:39], a[68:71], v[100:103]
  ds_read_b128 a[20:23], v16 offset:0
  v_mfma_f32_16x16x32_bf16 v[64:67], a[60:63], a[40:43], v[64:67]
  v_add_u32 v15, 10240, v15
  v_mfma_f32_16x16x32_bf16 v[84:87], a[64:67], a[40:43], v[84:87]
  v_add_u32 v17, 10240, v17
  v_mfma_f32_16x16x32_bf16 v[104:107], a[40:43], a[68:71], v[104:107]
  s_add_u32 s44, s44, 1
  v_mfma_f32_16x16x32_bf16 v[116:119], a[24:27], a[24:27], v[116:119]
  s_cmp_lt_u32 s44, 8
  v_mfma_f32_16x16x32_bf16 v[108:111], v[120:123], a[44:47], v[108:111]
  v_mfma_f32_16x16x32_bf16 v[112:115], a[44:47], a[44:47], v[112:115]
  s_cbranch_scc1 L_k1loop
  v_add_u32 v14, 81920, v4
  v_add_u32 v15, 16384, v7
  s_lshl_b32 s48, s40, 9
  v_lshlrev_b32 v22, 2, v1
  v_add_u32 v23, 384, v22
  v_lshlrev_b32 v12, 2, v2
  ds_bpermute_b32 v20, v12, v88
  ds_bpermute_b32 v21, v12, v116
  v_cndmask_b32 v113, v113, v114, s[70:71]
  v_cndmask_b32 v113, v113, v115, s[72:73]
  v_cndmask_b32 v117, v117, v118, s[70:71]
  v_cndmask_b32 v117, v117, v119, s[72:73]
  v_and_b32 v9, 3, v1
  v_cmp_ne_u32 vcc, 0, v9
  s_nop 1
  v_cndmask_b32 v112, v112, v113, vcc
  v_cndmask_b32 v118, v116, v117, vcc
  v_mov_b32_dpp v24, v48 row_newbcast:0 row_mask:0xf bank_mask:0xf
  v_mov_b32_dpp v28, v68 row_newbcast:0 row_mask:0xf bank_mask:0xf
  v_mov_b32_dpp v25, v49 row_newbcast:0 row_mask:0xf bank_mask:0xf
  v_mov_b32_dpp v29, v69 row_newbcast:0 row_mask:0xf bank_mask:0xf
  v_mov_b32_dpp v26, v50 row_newbcast:0 row_mask:0xf bank_mask:0xf
  v_mov_b32_dpp v30, v70 row_newbcast:0 row_mask:0xf bank_mask:0xf
  v_mov_b32_dpp v27, v51 row_newbcast:0 row_mask:0xf bank_mask:0xf
  v_mov_b32_dpp v31, v71 row_newbcast:0 row_mask:0xf bank_mask:0xf
  s_mov_b32 s48, 0x3b000000
  s_mov_b32 s49, 0x3727c5ac
  s_waitcnt lgkmcnt(0)
  v_mul_f32 v32, s48, v108
  v_mul_f32 v36, s48, v21
  v_mul_f32 v33, s48, v112
  v_mul_f32 v37, s48, v118
  v_fma_f32 v33, -v32, v32, v33
  v_fma_f32 v37, -v36, v36, v37
  v_max_f32 v33, 0, v33
  v_max_f32 v37, 0, v37
  v_add_f32 v33, s49, v33
  v_add_f32 v37, s49, v37
  v_rsq_f32 v34, v33
  v_rsq_f32 v38, v37
  v_mul_f32_e64 v35, -v32, v34
  v_mul_f32_e64 v39, -v36, v38
  v_lshlrev_b32 v11, 3, v2
  v_add_u32 v11, 147456, v11
  s_lshl_b32 s50, s42, 7
  v_add_u32 v12, s50, v11
  s_mov_b64 exec, s[66:67]
  ds_write_b64 v12, v[34:35] offset:128
  ds_write_b64 v11, v[38:39]
  s_mov_b64 exec, 1
  v_mov_b32 v9, 1
  s_waitcnt lgkmcnt(0)
  ds_add_u32 v8, v9 offset:40
  s_mov_b64 exec, -1
L_spin_1:
  ds_read_b32 v9, v8 offset:40
  s_waitcnt lgkmcnt(0)
  v_readfirstlane_b32 s50, v9
  s_nop 3
  s_cmp_lt_u32 s50, 4
  s_cbranch_scc1 L_spin_1
L_spin_1x:
  v_lshlrev_b32 v12, 5, v3
  v_add_u32 v12, 147456, v12
  ds_read_b64 v[32:33], v11 offset:0
  ds_read_b64 v[34:35], v11 offset:128
  ds_read_b64 v[36:37], v11 offset:256
  ds_read_b64 v[38:39], v11 offset:384
  ds_read_b64 v[40:41], v11 offset:512
  s_waitcnt lgkmcnt(0)
  ds_read_b128 v[108:111], v12 offset:0
  ds_read_b128 v[112:115], v12 offset:16
  ds_read_b128 v[116:119], v12 offset:128
  ds_read_b128 v[120:123], v12 offset:144
  v_pk_mul_f32 v[44:45], v[28:29], v[32:33] op_sel:[0,1] op_sel_hi:[1,1]
  v_pk_mul_f32 v[46:47], v[30:31], v[32:33] op_sel:[0,1] op_sel_hi:[1,1]
  v_pk_fma_f32 v[68:69], v[68:69], v[32:33], v[44:45] op_sel_hi:[1,0,1]
  v_pk_fma_f32 v[70:71], v[70:71], v[32:33], v[46:47] op_sel_hi:[1,0,1]
  v_cvt_pk_bf16_f32 v68, v68, v69
  v_cvt_pk_bf16_f32 v69, v70, v71
  v_pk_mul_f32 v[44:45], v[28:29], v[34:35] op_sel:[0,1] op_sel_hi:[1,1]
  v_pk_mul_f32 v[46:47], v[30:31], v[34:35] op_sel:[0,1] op_sel_hi:[1,1]
  v_pk_fma_f32 v[72:73], v[72:73], v[34:35], v[44:45] op_sel_hi:[1,0,1]
  v_pk_fma_f32 v[74:75], v[74:75], v[34:35], v[46:47] op_sel_hi:[1,0,1]
  v_cvt_pk_bf16_f32 v72, v72, v73
  v_cvt_pk_bf16_f32 v73, v74, v75
  v_pk_mul_f32 v[44:45], v[24:25], v[34:35] op_sel:[0,1] op_sel_hi:[1,1]
  v_pk_mul_f32 v[46:47], v[26:27], v[34:35] op_sel:[0,1] op_sel_hi:[1,1]
  v_pk_fma_f32 v[52:53], v[52:53], v[34:35], v[44:45] op_sel_hi:[1,0,1]
  v_pk_fma_f32 v[54:55], v[54:55], v[34:35], v[46:47] op_sel_hi:[1,0,1]
  v_cvt_pk_bf16_f32 v52, v52, v53
  v_cvt_pk_bf16_f32 v53, v54, v55
  v_pk_mul_f32 v[44:45], v[28:29], v[36:37] op_sel:[0,1] op_sel_hi:[1,1]
  v_pk_mul_f32 v[46:47], v[30:31], v[36:37] op_sel:[0,1] op_sel_hi:[1,1]
  v_pk_fma_f32 v[76:77], v[76:77], v[36:37], v[44:45] op_sel_hi:[1,0,1]
  v_pk_fma_f32 v[78:79], v[78:79], v[36:37], v[46:47] op_sel_hi:[1,0,1]
  v_cvt_pk_bf16_f32 v76, v76, v77
  v_cvt_pk_bf16_f32 v77, v78, v79
  v_pk_mul_f32 v[44:45], v[24:25], v[36:37] op_sel:[0,1] op_sel_hi:[1,1]
  v_pk_mul_f32 v[46:47], v[26:27], v[36:37] op_sel:[0,1] op_sel_hi:[1,1]
  v_pk_fma_f32 v[56:57], v[56:57], v[36:37], v[44:45] op_sel_hi:[1,0,1]
  v_pk_fma_f32 v[58:59], v[58:59], v[36:37], v[46:47] op_sel_hi:[1,0,1]
  v_cvt_pk_bf16_f32 v56, v56, v57
  v_cvt_pk_bf16_f32 v57, v58, v59
  v_pk_mul_f32 v[44:45], v[28:29], v[38:39] op_sel:[0,1] op_sel_hi:[1,1]
  v_pk_mul_f32 v[46:47], v[30:31], v[38:39] op_sel:[0,1] op_sel_hi:[1,1]
  v_pk_fma_f32 v[80:81], v[80:81], v[38:39], v[44:45] op_sel_hi:[1,0,1]
  v_pk_fma_f32 v[82:83], v[82:83], v[38:39], v[46:47] op_sel_hi:[1,0,1]
  v_cvt_pk_bf16_f32 v80, v80, v81
  v_cvt_pk_bf16_f32 v81, v82, v83
  v_pk_mul_f32 v[44:45], v[24:25], v[38:39] op_sel:[0,1] op_sel_hi:[1,1]
  v_pk_mul_f32 v[46:47], v[26:27], v[38:39] op_sel:[0,1] op_sel_hi:[1,1]
  v_pk_fma_f32 v[60:61], v[60:61], v[38:39], v[44:45] op_sel_hi:[1,0,1]
  v_pk_fma_f32 v[62:63], v[62:63], v[38:39], v[46:47] op_sel_hi:[1,0,1]
  v_cvt_pk_bf16_f32 v60, v60, v61
  v_cvt_pk_bf16_f32 v61, v62, v63
  v_pk_mul_f32 v[44:45], v[28:29], v[40:41] op_sel:[0,1] op_sel_hi:[1,1]
  v_pk_mul_f32 v[46:47], v[30:31], v[40:41] op_sel:[0,1] op_sel_hi:[1,1]
  v_pk_fma_f32 v[84:85], v[84:85], v[40:41], v[44:45] op_sel_hi:[1,0,1]
  v_pk_fma_f32 v[86:87], v[86:87], v[40:41], v[46:47] op_sel_hi:[1,0,1]
  v_cvt_pk_bf16_f32 v84, v84, v85
  v_cvt_pk_bf16_f32 v85, v86, v87
  v_pk_mul_f32 v[44:45], v[24:25], v[40:41] op_sel:[0,1] op_sel_hi:[1,1]
  v_pk_mul_f32 v[46:47], v[26:27], v[40:41] op_sel:[0,1] op_sel_hi:[1,1]
  v_pk_fma_f32 v[64:65], v[64:65], v[40:41], v[44:45] op_sel_hi:[1,0,1]
  v_pk_fma_f32 v[66:67], v[66:67], v[40:41], v[46:47] op_sel_hi:[1,0,1]
  v_cvt_pk_bf16_f32 v64, v64, v65
  v_cvt_pk_bf16_f32 v65, v66, v67
  s_waitcnt lgkmcnt(2)
  v_mul_f32 v44, v20, v109
  v_mul_f32 v45, v20, v111
  v_mul_f32 v46, v20, v113
  v_mul_f32 v47, v20, v115
  v_fma_f32 v88, v88, v108, v44
  v_fma_f32 v89, v89, v110, v45
  v_fma_f32 v90, v90, v112, v46
  v_fma_f32 v91, v91, v114, v47
  ds_read_b128 v[108:111], v12 offset:256
  ds_read_b128 v[112:115], v12 offset:272
  v_cvt_pk_bf16_f32 v88, v88, v89
  v_cvt_pk_bf16_f32 v89, v90, v91
  s_waitcnt lgkmcnt(2)
  v_mul_f32 v44, v20, v117
  v_mul_f32 v45, v20, v119
  v_mul_f32 v46, v20, v121
  v_mul_f32 v47, v20, v123
  v_fma_f32 v92, v92, v116, v44
  v_fma_f32 v93, v93, v118, v45
  v_fma_f32 v94, v94, v120, v46
  v_fma_f32 v95, v95, v122, v47
  ds_read_b128 v[116:119], v12 offset:384
  ds_read_b128 v[120:123], v12 offset:400
  v_cvt_pk_bf16_f32 v92, v92, v93
  v_cvt_pk_bf16_f32 v93, v94, v95
  s_waitcnt lgkmcnt(2)
  v_mul_f32 v44, v20, v109
  v_mul_f32 v45, v20, v111
  v_mul_f32 v46, v20, v113
  v_mul_f32 v47, v20, v115
  v_fma_f32 v96, v96, v108, v44
  v_fma_f32 v97, v97, v110, v45
  v_fma_f32 v98, v98, v112, v46
  v_fma_f32 v99, v99, v114, v47
  ds_read_b128 v[108:111], v12 offset:512
  ds_read_b128 v[112:115], v12 offset:528
  v_cvt_pk_bf16_f32 v96, v96, v97
  v_cvt_pk_bf16_f32 v97, v98, v99
  s_waitcnt lgkmcnt(2)
  v_mul_f32 v44, v20, v117
  v_mul_f32 v45, v20, v119
  v_mul_f32 v46, v20, v121
  v_mul_f32 v47, v20, v123
  v_fma_f32 v100, v100, v116, v44
  v_fma_f32 v101, v101, v118, v45
  v_fma_f32 v102, v102, v120, v46
  v_fma_f32 v103, v103, v122, v47
  v_cvt_pk_bf16_f32 v100, v100, v101
  v_cvt_pk_bf16_f32 v101, v102, v103
  s_waitcnt lgkmcnt(0)
  v_mul_f32 v44, v20, v109
  v_mul_f32 v45, v20, v111
  v_mul_f32 v46, v20, v113
  v_mul_f32 v47, v20, v115
  v_fma_f32 v104, v104, v108, v44
  v_fma_f32 v105, v105, v110, v45
  v_fma_f32 v106, v106, v112, v46
  v_fma_f32 v107, v107, v114, v47
  v_cvt_pk_bf16_f32 v104, v104, v105
  v_cvt_pk_bf16_f32 v105, v106, v107
  s_lshl_b32 s48, s40, 9
  v_lshlrev_b32 v9, 2, v1
  v_add_u32 v9, 384, v9
  s_mov_b64 exec, 0xff
  buffer_load_dword v111, v9, s[36:39], s48 offen sc1
  s_mov_b64 exec, -1
  v_mfma_f32_16x16x16_bf16 v[16:19], v[68:69], v[52:53], 0
  v_mfma_f32_16x16x16_bf16 v[20:23], v[72:73], v[52:53], 0
  v_mfma_f32_16x16x16_bf16 v[24:27], v[72:73], v[56:57], 0
  v_mfma_f32_16x16x16_bf16 v[28:31], v[76:77], v[56:57], 0
  v_mfma_f32_16x16x16_bf16 v[32:35], v[76:77], v[60:61], 0
  v_mfma_f32_16x16x16_bf16 v[36:39], v[80:81], v[60:61], 0
  v_mfma_f32_16x16x16_bf16 v[40:43], v[80:81], v[64:65], 0
  v_mfma_f32_16x16x16_bf16 v[44:47], v[84:85], v[64:65], 0
  v_mov_b32 v108, 0xff7fffff
  v_mov_b32 v120, 0x3f803f80
  v_mov_b32 v121, 0x3f803f80
  s_mov_b32 s48, 0x3eb8aa3b
  s_mov_b32 s49, s48
  v_mov_b32 v109, 0x0c0c0100
  v_mov_b32 v9, 0x01000c0c
  v_cndmask_b32 v109, v109, v9, s[74:75]
  v_mov_b32 v110, 0x0c0c0302
  v_mov_b32 v10, 0x03020c0c
  v_cndmask_b32 v110, v110, v10, s[74:75]
  v_cndmask_b32 v52, v16, v17, s[74:75]
  v_cndmask_b32 v53, v18, v19, s[74:75]
  v_cndmask_b32 v54, v20, v21, s[74:75]
  v_cndmask_b32 v55, v22, v23, s[74:75]
  v_cndmask_b32 v56, v24, v25, s[74:75]
  v_cndmask_b32 v57, v26, v27, s[74:75]
  v_cndmask_b32 v58, v28, v29, s[74:75]
  v_cndmask_b32 v59, v30, v31, s[74:75]
  v_cndmask_b32 v60, v32, v33, s[74:75]
  v_cndmask_b32 v61, v34, v35, s[74:75]
  v_cndmask_b32 v62, v36, v37, s[74:75]
  v_cndmask_b32 v63, v38, v39, s[74:75]
  v_cndmask_b32 v64, v40, v41, s[74:75]
  v_cndmask_b32 v65, v42, v43, s[74:75]
  v_cndmask_b32 v66, v44, v45, s[74:75]
  v_cndmask_b32 v67, v46, v47, s[74:75]
  v_cndmask_b32 v52, v108, v52, s[62:63]
  v_cndmask_b32 v53, v108, v53, s[64:65]
  v_cndmask_b32 v54, v108, v54, s[54:55]
  v_cndmask_b32 v55, v108, v55, s[56:57]
  v_cndmask_b32 v56, v108, v56, s[58:59]
  v_cndmask_b32 v57, v108, v57, s[60:61]
  v_cndmask_b32 v58, v108, v58, s[54:55]
  v_cndmask_b32 v59, v108, v59, s[56:57]
  v_cndmask_b32 v60, v108, v60, s[58:59]
  v_cndmask_b32 v61, v108, v61, s[60:61]
  v_cndmask_b32 v62, v108, v62, s[54:55]
  v_cndmask_b32 v63, v108, v63, s[56:57]
  v_cndmask_b32 v64, v108, v64, s[58:59]
  v_cndmask_b32 v65, v108, v65, s[60:61]
  v_cndmask_b32 v66, v108, v66, s[54:55]
  v_cndmask_b32 v67, v108, v67, s[56:57]
  v_max3_f32 v112, v52, v53, v54
  v_max3_f32 v114, v56, v57, v58
  v_max3_f32 v116, v60, v61, v62
  v_max3_f32 v118, v64, v65, v66
  v_max_f32 v112, v112, v55
  v_max_f32 v114, v114, v59
  v_max_f32 v116, v116, v63
  v_max_f32 v118, v118, v67
  v_mov_b32 v113, v112
  v_mov_b32 v115, v114
  v_mov_b32 v117, v116
  v_mov_b32 v119, v118
  v_permlane16_swap_b32 v112, v113
  v_permlane16_swap_b32 v114, v115
  v_permlane16_swap_b32 v116, v117
  v_permlane16_swap_b32 v118, v119
  v_max_f32 v112, v112, v113
  v_max_f32 v114, v114, v115
  v_max_f32 v116, v116, v117
  v_max_f32 v118, v118, v119
  v_mov_b32 v113, v112
  v_mov_b32 v115, v114
  v_mov_b32 v117, v116
  v_mov_b32 v119, v118
  v_permlane32_swap_b32 v112, v113
  v_permlane32_swap_b32 v114, v115
  v_permlane32_swap_b32 v116, v117
  v_permlane32_swap_b32 v118, v119
  v_max_f32 v112, v112, v113
  v_max_f32 v114, v114, v115
  v_max_f32 v116, v116, v117
  v_max_f32 v118, v118, v119
  v_mul_f32_e64 v112, -v112, s48
  v_mul_f32_e64 v114, -v114, s48
  v_mul_f32_e64 v116, -v116, s48
  v_mul_f32_e64 v118, -v118, s48
  v_pk_fma_f32 v[52:53], v[52:53], s[48:49], v[112:113] op_sel_hi:[1,1,0]
  v_pk_fma_f32 v[54:55], v[54:55], s[48:49], v[112:113] op_sel_hi:[1,1,0]
  v_pk_fma_f32 v[56:57], v[56:57], s[48:49], v[114:115] op_sel_hi:[1,1,0]
  v_pk_fma_f32 v[58:59], v[58:59], s[48:49], v[114:115] op_sel_hi:[1,1,0]
  v_pk_fma_f32 v[60:61], v[60:61], s[48:49], v[116:117] op_sel_hi:[1,1,0]
  v_pk_fma_f32 v[62:63], v[62:63], s[48:49], v[116:117] op_sel_hi:[1,1,0]
  v_pk_fma_f32 v[64:65], v[64:65], s[48:49], v[118:119] op_sel_hi:[1,1,0]
  v_pk_fma_f32 v[66:67], v[66:67], s[48:49], v[118:119] op_sel_hi:[1,1,0]
  v_exp_f32 v52, v52
  v_exp_f32 v53, v53
  v_exp_f32 v54, v54
  v_exp_f32 v55, v55
  v_exp_f32 v56, v56
  v_exp_f32 v57, v57
  v_exp_f32 v58, v58
  v_exp_f32 v59, v59
  v_exp_f32 v60, v60
  v_exp_f32 v61, v61
  v_exp_f32 v62, v62
  v_exp_f32 v63, v63
  v_exp_f32 v64, v64
  v_exp_f32 v65, v65
  v_exp_f32 v66, v66
  v_exp_f32 v67, v67
  v_cvt_pk_bf16_f32 v112, v52, v53
  v_cvt_pk_bf16_f32 v113, v54, v55
  v_cvt_pk_bf16_f32 v114, v56, v57
  v_cvt_pk_bf16_f32 v115, v58, v59
  v_cvt_pk_bf16_f32 v116, v60, v61
  v_cvt_pk_bf16_f32 v117, v62, v63
  v_cvt_pk_bf16_f32 v118, v64, v65
  v_cvt_pk_bf16_f32 v119, v66, v67
  v_perm_b32 v16, v112, v112, v109
  v_perm_b32 v17, v112, v112, v110
  v_perm_b32 v18, v113, v113, v109
  v_perm_b32 v19, v113, v113, v110
  v_perm_b32 v20, v114, v114, v109
  v_perm_b32 v21, v114, v114, v110
  v_perm_b32 v22, v115, v115, v109
  v_perm_b32 v23, v115, v115, v110
  v_perm_b32 v24, v116, v116, v109
  v_perm_b32 v25, v116, v116, v110
  v_perm_b32 v26, v117, v117, v109
  v_perm_b32 v27, v117, v117, v110
  v_perm_b32 v28, v118, v118, v109
  v_perm_b32 v29, v118, v118, v110
  v_perm_b32 v30, v119, v119, v109
  v_perm_b32 v31, v119, v119, v110
  v_mfma_f32_16x16x16_bf16 v[72:75], v[120:121], v[16:17], 0
  v_mfma_f32_16x16x16_bf16 v[76:79], v[120:121], v[20:21], 0
  v_mfma_f32_16x16x16_bf16 v[80:83], v[120:121], v[24:25], 0
  v_mfma_f32_16x16x16_bf16 v[84:87], v[120:121], v[28:29], 0
  v_mfma_f32_16x16x16_bf16 v[32:35], v[88:89], v[16:17], 0
  v_mfma_f32_16x16x16_bf16 v[36:39], v[92:93], v[20:21], 0
  v_mfma_f32_16x16x16_bf16 v[40:43], v[96:97], v[24:25], 0
  v_mfma_f32_16x16x16_bf16 v[44:47], v[100:101], v[28:29], 0
  v_mfma_f32_16x16x16_bf16 v[72:75], v[120:121], v[18:19], v[72:75]
  v_mfma_f32_16x16x16_bf16 v[76:79], v[120:121], v[22:23], v[76:79]
  v_mfma_f32_16x16x16_bf16 v[80:83], v[120:121], v[26:27], v[80:83]
  v_mfma_f32_16x16x16_bf16 v[84:87], v[120:121], v[30:31], v[84:87]
  v_mfma_f32_16x16x16_bf16 v[32:35], v[92:93], v[18:19], v[32:35]
  v_mfma_f32_16x16x16_bf16 v[36:39], v[96:97], v[22:23], v[36:39]
  v_mfma_f32_16x16x16_bf16 v[40:43], v[100:101], v[26:27], v[40:43]
  v_mfma_f32_16x16x16_bf16 v[44:47], v[104:105], v[30:31], v[44:47]
  v_lshrrev_b32 v12, 1, v3
  s_and_b32 s50, s42, 1
  s_lshl_b32 s50, s50, 1
  v_add_u32 v12, s50, v12
  v_lshl_add_u32 v12, v12, 4, v2
  v_lshlrev_b32 v12, 4, v12
  v_and_b32 v10, 1, v3
  v_lshl_add_u32 v12, v10, 3, v12
  s_getreg_b32 s43, hwreg(HW_REG_XCC_ID, 0, 4)
  s_add_u32 s43, s43, 1
  s_lshl_b32 s48, s40, 9
  v_lshlrev_b32 v9, 2, v1
  v_add_u32 v9, 384, v9
  s_mov_b64 exec, 0xff
  s_waitcnt vmcnt(0)
  v_mov_b32 v10, v111
  v_cmp_eq_u32 vcc, 0, v10
  s_nop 3
  s_cmp_eq_u64 vcc, 0
  s_cbranch_scc1 L_modepollx
L_modepoll:
  buffer_load_dword v10, v9, s[36:39], s48 offen sc1
  s_waitcnt vmcnt(0)
  v_cmp_eq_u32 vcc, 0, v10
  s_nop 3
  s_cmp_lg_u64 vcc, 0
  s_cbranch_scc1 L_modepoll
L_modepollx:
  v_cmp_ne_u32 vcc, s43, v10
  s_nop 3
  s_cmp_eq_u64 vcc, 0
  s_cselect_b32 s43, 1, 0
  s_mov_b64 exec, -1
  v_rcp_f32 v72, v72
  v_rcp_f32 v76, v76
  v_rcp_f32 v80, v80
  v_rcp_f32 v84, v84
  v_pk_mul_f32 v[32:33], v[32:33], v[72:73] op_sel_hi:[1,0]
  v_pk_mul_f32 v[34:35], v[34:35], v[72:73] op_sel_hi:[1,0]
  v_pk_mul_f32 v[36:37], v[36:37], v[76:77] op_sel_hi:[1,0]
  v_pk_mul_f32 v[38:39], v[38:39], v[76:77] op_sel_hi:[1,0]
  v_pk_mul_f32 v[40:41], v[40:41], v[80:81] op_sel_hi:[1,0]
  v_pk_mul_f32 v[42:43], v[42:43], v[80:81] op_sel_hi:[1,0]
  v_pk_mul_f32 v[44:45], v[44:45], v[84:85] op_sel_hi:[1,0]
  v_pk_mul_f32 v[46:47], v[46:47], v[84:85] op_sel_hi:[1,0]
  v_cvt_pk_bf16_f32 v16, v32, v33
  v_cvt_pk_bf16_f32 v17, v34, v35
  v_cvt_pk_bf16_f32 v20, v36, v37
  v_cvt_pk_bf16_f32 v21, v38, v39
  v_cvt_pk_bf16_f32 v24, v40, v41
  v_cvt_pk_bf16_f32 v25, v42, v43
  v_cvt_pk_bf16_f32 v28, v44, v45
  v_cvt_pk_bf16_f32 v29, v46, v47
  s_lshl_b32 s48, s41, 1
  s_lshr_b32 s49, s42, 1
  s_add_u32 s48, s48, s49
  s_lshl_b32 s48, s48, 10
  s_add_u32 s48, s48, s3
  s_add_u32 s48, s48, 8388608
  s_cmp_eq_u32 s43, 1
  s_cbranch_scc1 L_fast_2
  s_add_u32 s49, s48, 0
  buffer_store_dwordx2 v[16:17], v12, s[36:39], s49 offen sc1
  s_add_u32 s49, s48, 16384
  buffer_store_dwordx2 v[20:21], v12, s[36:39], s49 offen sc1
  s_add_u32 s49, s48, 32768
  buffer_store_dwordx2 v[24:25], v12, s[36:39], s49 offen sc1
  s_add_u32 s49, s48, 49152
  buffer_store_dwordx2 v[28:29], v12, s[36:39], s49 offen sc1
  s_branch L_stend_3
L_fast_2:
  s_add_u32 s49, s48, 0
  buffer_store_dwordx2 v[16:17], v12, s[36:39], s49 offen
  s_add_u32 s49, s48, 16384
  buffer_store_dwordx2 v[20:21], v12, s[36:39], s49 offen
  s_add_u32 s49, s48, 32768
  buffer_store_dwordx2 v[24:25], v12, s[36:39], s49 offen
  s_add_u32 s49, s48, 49152
  buffer_store_dwordx2 v[28:29], v12, s[36:39], s49 offen
L_stend_3:
  v_mov_b32 v9, 1
  v_mov_b32 v10, 0
  s_waitcnt vmcnt(0)
  s_mov_b64 exec, 1
  s_cmp_eq_u32 s43, 1
  s_cbranch_scc1 L_fast_4
  buffer_store_dword v9, v10, s[36:39], s76 offen sc1
  s_branch L_stend_5
L_fast_4:
  buffer_store_dword v9, v10, s[36:39], s76 offen
L_stend_5:
  s_mov_b64 exec, -1
  s_lshr_b32 s48, s41, 2
  s_and_b32 s49, s41, 3
  s_lshl_b32 s50, s48, 15
  s_add_u32 s50, s50, s52
  s_lshl_b32 s51, s49, 8
  s_add_u32 s50, s50, s51
  s_lshl_b32 s51, s42, 6
  s_add_u32 s50, s50, s51
  v_lshlrev_b32 v9, 10, v2
  v_lshl_add_u32 v9, v3, 4, v9
  buffer_load_dwordx4 v[16:19], v9, s[8:11], s50 offen
  s_add_u32 s50, s50, 16384
  buffer_load_dwordx4 v[20:23], v9, s[8:11], s50 offen
  s_cmp_le_u32 s84, 0
  s_cbranch_scc1 L_fsl_7
L_fok_6:
  ds_read_b32 v125, v126
  ds_read_b64_tr_b16 a[0:1], v7 offset:0
  ds_read_b64_tr_b16 a[2:3], v7 offset:256
  ds_read_b64_tr_b16 a[4:5], v7 offset:8
  ds_read_b64_tr_b16 a[6:7], v7 offset:264
  ds_read_b64_tr_b16 a[8:9], v7 offset:2048
  ds_read_b64_tr_b16 a[10:11], v7 offset:2304
  ds_read_b64_tr_b16 a[12:13], v7 offset:2056
  ds_read_b64_tr_b16 a[14:15], v7 offset:2312
  s_waitcnt lgkmcnt(8)
  v_readfirstlane_b32 s84, v125
  s_nop 3
  s_cmp_le_u32 s84, 1
  s_cbranch_scc1 L_fsl_9
L_fok_8:
  ds_read_b32 v125, v126
  ds_read_b64_tr_b16 a[16:17], v7 offset:16384
  ds_read_b64_tr_b16 a[18:19], v7 offset:16640
  ds_read_b64_tr_b16 a[20:21], v7 offset:16392
  ds_read_b64_tr_b16 a[22:23], v7 offset:16648
  ds_read_b64_tr_b16 a[24:25], v7 offset:18432
  ds_read_b64_tr_b16 a[26:27], v7 offset:18688
  ds_read_b64_tr_b16 a[28:29], v7 offset:18440
  ds_read_b64_tr_b16 a[30:31], v7 offset:18696
  s_waitcnt lgkmcnt(9)
  v_mov_b32 v13, 1
  ds_write_b32 v126, v13 offset:16
  s_waitcnt lgkmcnt(9)
  v_readfirstlane_b32 s84, v125
  s_nop 3
  s_cmp_le_u32 s84, 2
  s_cbranch_scc1 L_fsl_11
L_fok_10:
  ds_read_b32 v125, v126
  ds_read_b64_tr_b16 a[32:33], v7 offset:32768
  ds_read_b64_tr_b16 a[34:35], v7 offset:33024
  ds_read_b64_tr_b16 a[36:37], v7 offset:32776
  ds_read_b64_tr_b16 a[38:39], v7 offset:33032
  ds_read_b64_tr_b16 a[40:41], v7 offset:34816
  ds_read_b64_tr_b16 a[42:43], v7 offset:35072
  ds_read_b64_tr_b16 a[44:45], v7 offset:34824
  ds_read_b64_tr_b16 a[46:47], v7 offset:35080
  s_waitcnt lgkmcnt(10)
  v_mov_b32 v13, 2
  ds_write_b32 v126, v13 offset:16
  s_waitcnt lgkmcnt(9)
  v_readfirstlane_b32 s84, v125
  s_nop 3
  s_cmp_le_u32 s84, 3
  s_cbranch_scc1 L_fsl_13
L_fok_12:
  ds_read_b32 v125, v126
  ds_read_b64_tr_b16 a[48:49], v7 offset:49152
  ds_read_b64_tr_b16 a[50:51], v7 offset:49408
  ds_read_b64_tr_b16 a[52:53], v7 offset:49160
  ds_read_b64_tr_b16 a[54:55], v7 offset:49416
  ds_read_b64_tr_b16 a[56:57], v7 offset:51200
  ds_read_b64_tr_b16 a[58:59], v7 offset:51456
  ds_read_b64_tr_b16 a[60:61], v7 offset:51208
  ds_read_b64_tr_b16 a[62:63], v7 offset:51464
  s_waitcnt lgkmcnt(10)
  v_mov_b32 v13, 3
  ds_write_b32 v126, v13 offset:16
  s_waitcnt lgkmcnt(9)
  v_readfirstlane_b32 s84, v125
  s_nop 3
  s_cmp_le_u32 s84, 4
  s_cbranch_scc1 L_fsl_15
L_fok_14:
  ds_read_b32 v125, v126
  ds_read_b64_tr_b16 a[64:65], v15 offset:49152
  ds_read_b64_tr_b16 a[66:67], v15 offset:49408
  ds_read_b64_tr_b16 a[68:69], v15 offset:49160
  ds_read_b64_tr_b16 a[70:71], v15 offset:49416
  ds_read_b64_tr_b16 a[72:73], v15 offset:51200
  ds_read_b64_tr_b16 a[74:75], v15 offset:51456
  ds_read_b64_tr_b16 a[76:77], v15 offset:51208
  ds_read_b64_tr_b16 a[78:79], v15 offset:51464
  s_waitcnt lgkmcnt(10)
  v_mov_b32 v13, 4
  ds_write_b32 v126, v13 offset:16
  v_add_u32 v15, 16384, v5
  v_xor_b32 v124, 64, v15
  s_lshl_b32 s48, s40, 9
  s_add_u32 s48, s48, 0
  v_lshlrev_b32 v10, 2, v1
  s_mov_b64 exec, 0xffffffff
L_poll_16:
  buffer_load_dword v9, v10, s[36:39], s48 offen sc1
  s_waitcnt vmcnt(0)
  v_cmp_eq_u32 vcc, 0, v9
  s_nop 3
  s_cmp_lg_u64 vcc, 0
  s_cbranch_scc1 L_poll_16
L_poll_16x:
  s_mov_b64 exec, -1
  s_lshr_b32 s48, s41, 2
  s_lshl_b32 s48, s48, 15
  s_add_u32 s48, s48, s3
  s_add_u32 s48, s48, 8388608
  s_lshr_b32 s49, s42, 1
  s_lshl_b32 s49, s49, 14
  s_add_u32 s48, s48, s49
  s_and_b32 s50, s42, 1
  s_lshl_b32 s50, s50, 13
  s_add_u32 s49, s49, s50
  s_add_u32 s49, s49, 81920
  s_lshr_b32 s51, s40, 3
  s_lshl_b32 s51, s51, 1
  s_lshr_b32 s44, s41, 2
  s_add_u32 s51, s51, s44
  s_and_b32 s51, s51, 7
  s_lshl_b32 s51, s51, 11
  s_add_u32 s51, s51, s50
  s_add_u32 s44, s51, 0
  s_and_b32 s44, s44, 16383
  s_add_u32 s44, s44, s48
  s_add_u32 m0, s49, 0
  s_nop 0
  buffer_load_dwordx4 v4, s[36:39], s44 offen offset:0 sc1 lds
  buffer_load_dwordx4 v4, s[36:39], s44 offen offset:1024 sc1 lds
  s_add_u32 s44, s51, 2048
  s_and_b32 s44, s44, 16383
  s_add_u32 s44, s44, s48
  s_add_u32 m0, s49, 2048
  s_nop 0
  buffer_load_dwordx4 v4, s[36:39], s44 offen offset:0 sc1 lds
  buffer_load_dwordx4 v4, s[36:39], s44 offen offset:1024 sc1 lds
  s_add_u32 s44, s51, 4096
  s_and_b32 s44, s44, 16383
  s_add_u32 s44, s44, s48
  s_add_u32 m0, s49, 4096
  s_nop 0
  buffer_load_dwordx4 v4, s[36:39], s44 offen offset:0 sc1 lds
  buffer_load_dwordx4 v4, s[36:39], s44 offen offset:1024 sc1 lds
  s_add_u32 s44, s51, 6144
  s_and_b32 s44, s44, 16383
  s_add_u32 s44, s44, s48
  s_add_u32 m0, s49, 6144
  s_nop 0
  buffer_load_dwordx4 v4, s[36:39], s44 offen offset:0 sc1 lds
  buffer_load_dwordx4 v4, s[36:39], s44 offen offset:1024 sc1 lds
  s_waitcnt lgkmcnt(9)
  v_readfirstlane_b32 s84, v125
  s_nop 3
  s_cmp_le_u32 s84, 5
  s_cbranch_scc1 L_fsl_18
L_fok_17:
  ds_read_b32 v125, v126
  ds_read_b64_tr_b16 a[80:81], v7 offset:0
  ds_read_b64_tr_b16 a[82:83], v7 offset:256
  ds_read_b64_tr_b16 a[84:85], v7 offset:8
  ds_read_b64_tr_b16 a[86:87], v7 offset:264
  ds_read_b64_tr_b16 a[88:89], v7 offset:2048
  ds_read_b64_tr_b16 a[90:91], v7 offset:2304
  ds_read_b64_tr_b16 a[92:93], v7 offset:2056
  ds_read_b64_tr_b16 a[94:95], v7 offset:2312
  s_waitcnt lgkmcnt(10)
  v_mov_b32 v13, 5
  ds_write_b32 v126, v13 offset:16
  s_waitcnt lgkmcnt(9)
  v_readfirstlane_b32 s84, v125
  s_nop 3
  s_cmp_le_u32 s84, 6
  s_cbranch_scc1 L_fsl_20
L_fok_19:
  ds_read_b32 v125, v126
  ds_read_b64_tr_b16 a[96:97], v7 offset:16384
  ds_read_b64_tr_b16 a[98:99], v7 offset:16640
  ds_read_b64_tr_b16 a[100:101], v7 offset:16392
  ds_read_b64_tr_b16 a[102:103], v7 offset:16648
  ds_read_b64_tr_b16 a[104:105], v7 offset:18432
  ds_read_b64_tr_b16 a[106:107], v7 offset:18688
  ds_read_b64_tr_b16 a[108:109], v7 offset:18440
  ds_read_b64_tr_b16 a[110:111], v7 offset:18696
  s_waitcnt lgkmcnt(10)
  v_mov_b32 v13, 6
  ds_write_b32 v126, v13 offset:16
  s_waitcnt lgkmcnt(9)
  v_readfirstlane_b32 s84, v125
  s_nop 3
  s_cmp_le_u32 s84, 7
  s_cbranch_scc1 L_fsl_22
L_fok_21:
  ds_read_b32 v125, v126
  ds_read_b64_tr_b16 a[112:113], v7 offset:32768
  ds_read_b64_tr_b16 a[114:115], v7 offset:33024
  ds_read_b64_tr_b16 a[116:117], v7 offset:32776
  ds_read_b64_tr_b16 a[118:119], v7 offset:33032
  ds_read_b64_tr_b16 a[120:121], v7 offset:34816
  ds_read_b64_tr_b16 a[122:123], v7 offset:35072
  ds_read_b64_tr_b16 a[124:125], v7 offset:34824
  ds_read_b64_tr_b16 a[126:127], v7 offset:35080
  s_waitcnt lgkmcnt(10)
  v_mov_b32 v13, 7
  ds_write_b32 v126, v13 offset:16
  s_waitcnt lgkmcnt(1)
  v_mov_b32 v13, 8
  ds_write_b32 v126, v13 offset:16
  v_add_u32 v15, 16384, v5
  v_xor_b32 v124, 64, v15
  s_waitcnt vmcnt(0)
  v_mov_b32 v9, 1
  s_mov_b64 exec, 1
  ds_add_u32 v8, v9 offset:32
  s_mov_b64 exec, -1
L_spin_23:
  ds_read_b32 v9, v8 offset:32
  s_waitcnt lgkmcnt(0)
  v_readfirstlane_b32 s50, v9
  s_nop 3
  s_cmp_lt_u32 s50, 4
  s_cbranch_scc1 L_spin_23
L_spin_23x:
  ds_read_b128 v[48:51], v14 offset:0
  ds_read_b128 v[52:55], v14 offset:16384
  ds_read_b128 v[56:59], v14 offset:1024
  ds_read_b128 v[60:63], v14 offset:17408
  ds_read_b128 v[64:67], v14 offset:2048
  ds_read_b128 v[68:71], v14 offset:18432
  s_waitcnt lgkmcnt(5)
  v_mfma_f32_16x16x32_bf16 v[32:35], a[0:3], v[48:51], 0
  ds_read_b128 v[72:75], v14 offset:3072
  v_mfma_f32_16x16x32_bf16 v[36:39], a[4:7], v[48:51], 0
  s_waitcnt lgkmcnt(5)
  v_mfma_f32_16x16x32_bf16 v[40:43], a[0:3], v[52:55], 0
  ds_read_b128 v[76:79], v14 offset:19456
  v_mfma_f32_16x16x32_bf16 v[44:47], a[4:7], v[52:55], 0
  s_waitcnt lgkmcnt(5)
  v_mfma_f32_16x16x32_bf16 v[32:35], a[8:11], v[56:59], v[32:35]
  ds_read_b128 v[48:51], v14 offset:4096
  v_mfma_f32_16x16x32_bf16 v[36:39], a[12:15], v[56:59], v[36:39]
  s_waitcnt lgkmcnt(5)
  v_mfma_f32_16x16x32_bf16 v[40:43], a[8:11], v[60:63], v[40:43]
  ds_read_b128 v[52:55], v14 offset:20480
  v_mfma_f32_16x16x32_bf16 v[44:47], a[12:15], v[60:63], v[44:47]
  s_waitcnt lgkmcnt(5)
  v_mfma_f32_16x16x32_bf16 v[32:35], a[16:19], v[64:67], v[32:35]
  ds_read_b128 v[56:59], v14 offset:5120
  v_mfma_f32_16x16x32_bf16 v[36:39], a[20:23], v[64:67], v[36:39]
  s_waitcnt lgkmcnt(5)
  v_mfma_f32_16x16x32_bf16 v[40:43], a[16:19], v[68:71], v[40:43]
  ds_read_b128 v[60:63], v14 offset:21504
  v_mfma_f32_16x16x32_bf16 v[44:47], a[20:23], v[68:71], v[44:47]
  s_waitcnt lgkmcnt(5)
  v_mfma_f32_16x16x32_bf16 v[32:35], a[24:27], v[72:75], v[32:35]
  ds_read_b128 v[64:67], v14 offset:6144
  v_mfma_f32_16x16x32_bf16 v[36:39], a[28:31], v[72:75], v[36:39]
  s_waitcnt lgkmcnt(5)
  v_mfma_f32_16x16x32_bf16 v[40:43], a[24:27], v[76:79], v[40:43]
  ds_read_b128 v[68:71], v14 offset:22528
  v_mfma_f32_16x16x32_bf16 v[44:47], a[28:31], v[76:79], v[44:47]
  s_waitcnt lgkmcnt(5)
  v_mfma_f32_16x16x32_bf16 v[32:35], a[32:35], v[48:51], v[32:35]
  ds_read_b128 v[72:75], v14 offset:7168
  v_mfma_f32_16x16x32_bf16 v[36:39], a[36:39], v[48:51], v[36:39]
  s_waitcnt lgkmcnt(5)
  v_mfma_f32_16x16x32_bf16 v[40:43], a[32:35], v[52:55], v[40:43]
  ds_read_b128 v[76:79], v14 offset:23552
  v_mfma_f32_16x16x32_bf16 v[44:47], a[36:39], v[52:55], v[44:47]
  s_waitcnt lgkmcnt(5)
  v_mfma_f32_16x16x32_bf16 v[32:35], a[40:43], v[56:59], v[32:35]
  ds_read_b128 v[48:51], v14 offset:8192
  v_mfma_f32_16x16x32_bf16 v[36:39], a[44:47], v[56:59], v[36:39]
  s_waitcnt lgkmcnt(5)
  v_mfma_f32_16x16x32_bf16 v[40:43], a[40:43], v[60:63], v[40:43]
  ds_read_b128 v[52:55], v14 offset:24576
  v_mfma_f32_16x16x32_bf16 v[44:47], a[44:47], v[60:63], v[44:47]
  s_waitcnt lgkmcnt(5)
  v_mfma_f32_16x16x32_bf16 v[32:35], a[48:51], v[64:67], v[32:35]
  ds_read_b128 v[56:59], v14 offset:9216
  v_mfma_f32_16x16x32_bf16 v[36:39], a[52:55], v[64:67], v[36:39]
  s_waitcnt lgkmcnt(5)
  v_mfma_f32_16x16x32_bf16 v[40:43], a[48:51], v[68:71], v[40:43]
  ds_read_b128 v[60:63], v14 offset:25600
  v_mfma_f32_16x16x32_bf16 v[44:47], a[52:55], v[68:71], v[44:47]
  s_waitcnt lgkmcnt(5)
  v_mfma_f32_16x16x32_bf16 v[32:35], a[56:59], v[72:75], v[32:35]
  ds_read_b128 v[64:67], v14 offset:10240
  v_mfma_f32_16x16x32_bf16 v[36:39], a[60:63], v[72:75], v[36:39]
  s_waitcnt lgkmcnt(5)
  v_mfma_f32_16x16x32_bf16 v[40:43], a[56:59], v[76:79], v[40:43]
  ds_read_b128 v[68:71], v14 offset:26624
  v_mfma_f32_16x16x32_bf16 v[44:47], a[60:63], v[76:79], v[44:47]
  s_waitcnt lgkmcnt(5)
  v_mfma_f32_16x16x32_bf16 v[32:35], a[64:67], v[48:51], v[32:35]
  ds_read_b128 v[72:75], v14 offset:11264
  v_mfma_f32_16x16x32_bf16 v[36:39], a[68:71], v[48:51], v[36:39]
  s_waitcnt lgkmcnt(5)
  v_mfma_f32_16x16x32_bf16 v[40:43], a[64:67], v[52:55], v[40:43]
  ds_read_b128 v[76:79], v14 offset:27648
  v_mfma_f32_16x16x32_bf16 v[44:47], a[68:71], v[52:55], v[44:47]
  s_waitcnt lgkmcnt(5)
  v_mfma_f32_16x16x32_bf16 v[32:35], a[72:75], v[56:59], v[32:35]
  ds_read_b128 v[48:51], v14 offset:12288
  v_mfma_f32_16x16x32_bf16 v[36:39], a[76:79], v[56:59], v[36:39]
  s_waitcnt lgkmcnt(5)
  v_mfma_f32_16x16x32_bf16 v[40:43], a[72:75], v[60:63], v[40:43]
  ds_read_b128 v[52:55], v14 offset:28672
  v_mfma_f32_16x16x32_bf16 v[44:47], a[76:79], v[60:63], v[44:47]
  s_waitcnt lgkmcnt(5)
  v_mfma_f32_16x16x32_bf16 v[32:35], a[80:83], v[64:67], v[32:35]
  ds_read_b128 v[56:59], v14 offset:13312
  v_mfma_f32_16x16x32_bf16 v[36:39], a[84:87], v[64:67], v[36:39]
  s_waitcnt lgkmcnt(5)
  v_mfma_f32_16x16x32_bf16 v[40:43], a[80:83], v[68:71], v[40:43]
  ds_read_b128 v[60:63], v14 offset:29696
  v_mfma_f32_16x16x32_bf16 v[44:47], a[84:87], v[68:71], v[44:47]
  s_waitcnt lgkmcnt(5)
  v_mfma_f32_16x16x32_bf16 v[32:35], a[88:91], v[72:75], v[32:35]
  ds_read_b128 v[64:67], v14 offset:14336
  v_mfma_f32_16x16x32_bf16 v[36:39], a[92:95], v[72:75], v[36:39]
  s_waitcnt lgkmcnt(5)
  v_mfma_f32_16x16x32_bf16 v[40:43], a[88:91], v[76:79], v[40:43]
  ds_read_b128 v[68:71], v14 offset:30720
  v_mfma_f32_16x16x32_bf16 v[44:47], a[92:95], v[76:79], v[44:47]
  s_waitcnt lgkmcnt(5)
  v_mfma_f32_16x16x32_bf16 v[32:35], a[96:99], v[48:51], v[32:35]
  ds_read_b128 v[72:75], v14 offset:15360
  v_mfma_f32_16x16x32_bf16 v[36:39], a[100:103], v[48:51], v[36:39]
  s_waitcnt lgkmcnt(5)
  v_mfma_f32_16x16x32_bf16 v[40:43], a[96:99], v[52:55], v[40:43]
  ds_read_b128 v[76:79], v14 offset:31744
  v_mfma_f32_16x16x32_bf16 v[44:47], a[100:103], v[52:55], v[44:47]
  s_waitcnt lgkmcnt(5)
  v_mfma_f32_16x16x32_bf16 v[32:35], a[104:107], v[56:59], v[32:35]
  v_mfma_f32_16x16x32_bf16 v[36:39], a[108:111], v[56:59], v[36:39]
  s_waitcnt lgkmcnt(4)
  v_mfma_f32_16x16x32_bf16 v[40:43], a[104:107], v[60:63], v[40:43]
  v_mfma_f32_16x16x32_bf16 v[44:47], a[108:111], v[60:63], v[44:47]
  s_waitcnt lgkmcnt(3)
  v_mfma_f32_16x16x32_bf16 v[32:35], a[112:115], v[64:67], v[32:35]
  v_mfma_f32_16x16x32_bf16 v[36:39], a[116:119], v[64:67], v[36:39]
  s_waitcnt lgkmcnt(2)
  v_mfma_f32_16x16x32_bf16 v[40:43], a[112:115], v[68:71], v[40:43]
  v_mfma_f32_16x16x32_bf16 v[44:47], a[116:119], v[68:71], v[44:47]
  s_waitcnt lgkmcnt(1)
  v_mfma_f32_16x16x32_bf16 v[32:35], a[120:123], v[72:75], v[32:35]
  v_mfma_f32_16x16x32_bf16 v[36:39], a[124:127], v[72:75], v[36:39]
  s_waitcnt lgkmcnt(0)
  v_mfma_f32_16x16x32_bf16 v[40:43], a[120:123], v[76:79], v[40:43]
  v_mfma_f32_16x16x32_bf16 v[44:47], a[124:127], v[76:79], v[44:47]
  v_lshlrev_b32 v48, 16, v16
  v_and_b32 v49, 0xffff0000, v16
  v_lshlrev_b32 v50, 16, v17
  v_and_b32 v51, 0xffff0000, v17
  v_lshlrev_b32 v52, 16, v18
  v_and_b32 v53, 0xffff0000, v18
  v_lshlrev_b32 v54, 16, v19
  v_and_b32 v55, 0xffff0000, v19
  v_lshlrev_b32 v56, 16, v20
  v_and_b32 v57, 0xffff0000, v20
  v_lshlrev_b32 v58, 16, v21
  v_and_b32 v59, 0xffff0000, v21
  v_lshlrev_b32 v60, 16, v22
  v_and_b32 v61, 0xffff0000, v22
  v_lshlrev_b32 v62, 16, v23
  v_and_b32 v63, 0xffff0000, v23
  v_pk_add_f32 v[48:49], v[48:49], v[32:33]
  v_pk_add_f32 v[50:51], v[50:51], v[34:35]
  v_pk_add_f32 v[52:53], v[52:53], v[36:37]
  v_pk_add_f32 v[54:55], v[54:55], v[38:39]
  v_pk_add_f32 v[56:57], v[56:57], v[40:41]
  v_pk_add_f32 v[58:59], v[58:59], v[42:43]
  v_pk_add_f32 v[60:61], v[60:61], v[44:45]
  v_pk_add_f32 v[62:63], v[62:63], v[46:47]
  v_cvt_pk_bf16_f32 v16, v48, v49
  v_cvt_pk_bf16_f32 v17, v50, v51
  v_cvt_pk_bf16_f32 v18, v52, v53
  v_cvt_pk_bf16_f32 v19, v54, v55
  v_cvt_pk_bf16_f32 v20, v56, v57
  v_cvt_pk_bf16_f32 v21, v58, v59
  v_cvt_pk_bf16_f32 v22, v60, v61
  v_cvt_pk_bf16_f32 v23, v62, v63
  s_lshr_b32 s48, s41, 2
  s_lshl_b32 s48, s48, 15
  s_add_u32 s48, s48, s53
  s_and_b32 s49, s41, 3
  s_lshl_b32 s49, s49, 2
  s_add_u32 s49, s49, s42
  s_lshl_b32 s50, s49, 10
  s_add_u32 s48, s48, s50
  s_add_u32 s48, s48, 4194304
  s_cmp_eq_u32 s43, 1
  s_cbranch_scc1 L_fast_24
  buffer_store_dwordx4 v[16:19], v4, s[36:39], s48 offen sc1
  s_add_u32 s50, s48, 16384
  buffer_store_dwordx4 v[20:23], v4, s[36:39], s50 offen sc1
  s_branch L_stend_25
L_fast_24:
  buffer_store_dwordx4 v[16:19], v4, s[36:39], s48 offen
  s_add_u32 s50, s48, 16384
  buffer_store_dwordx4 v[20:23], v4, s[36:39], s50 offen
L_stend_25:
  v_pk_add_f32 v[32:33], v[48:49], v[50:51]
  v_pk_add_f32 v[36:37], v[56:57], v[58:59]
  v_pk_add_f32 v[34:35], v[52:53], v[54:55]
  v_pk_add_f32 v[38:39], v[60:61], v[62:63]
  v_pk_add_f32 v[32:33], v[32:33], v[34:35]
  v_pk_add_f32 v[36:37], v[36:37], v[38:39]
  v_pk_mul_f32 v[34:35], v[48:49], v[48:49]
  v_pk_mul_f32 v[38:39], v[56:57], v[56:57]
  v_add_f32 v32, v32, v33
  v_add_f32 v36, v36, v37
  v_pk_fma_f32 v[34:35], v[50:51], v[50:51], v[34:35]
  v_pk_fma_f32 v[38:39], v[58:59], v[58:59], v[38:39]
  v_pk_fma_f32 v[34:35], v[52:53], v[52:53], v[34:35]
  v_pk_fma_f32 v[38:39], v[60:61], v[60:61], v[38:39]
  v_pk_fma_f32 v[34:35], v[54:55], v[54:55], v[34:35]
  v_pk_fma_f32 v[38:39], v[62:63], v[62:63], v[38:39]
  v_add_f32 v33, v34, v35
  v_add_f32 v37, v38, v39
  v_mov_b32 v34, v32
  v_mov_b32 v35, v33
  v_mov_b32 v38, v36
  v_mov_b32 v39, v37
  v_permlane16_swap_b32 v32, v34
  v_permlane16_swap_b32 v33, v35
  v_permlane16_swap_b32 v36, v38
  v_permlane16_swap_b32 v37, v39
  v_pk_add_f32 v[32:33], v[32:33], v[34:35]
  v_pk_add_f32 v[36:37], v[36:37], v[38:39]
  v_mov_b32 v34, v32
  v_mov_b32 v35, v33
  v_mov_b32 v38, v36
  v_mov_b32 v39, v37
  v_permlane32_swap_b32 v32, v34
  v_permlane32_swap_b32 v33, v35
  v_permlane32_swap_b32 v36, v38
  v_permlane32_swap_b32 v37, v39
  v_pk_add_f32 v[32:33], v[32:33], v[34:35]
  v_pk_add_f32 v[36:37], v[36:37], v[38:39]
  s_lshr_b32 s48, s41, 2
  s_lshl_b32 s48, s48, 12
  s_lshl_b32 s50, s40, 13
  s_add_u32 s48, s48, s50
  s_lshl_b32 s49, s49, 3
  s_add_u32 s48, s48, s49
  s_add_u32 s48, s48, 7340032
  v_lshlrev_b32 v9, 7, v2
  s_mov_b64 exec, 0xffff
  s_cmp_eq_u32 s43, 1
  s_cbranch_scc1 L_fast_26
  buffer_store_dwordx2 v[32:33], v9, s[36:39], s48 offen sc1
  buffer_store_dwordx2 v[36:37], v9, s[36:39], s48 offen offset:2048 sc1
  s_branch L_stend_27
L_fast_26:
  buffer_store_dwordx2 v[32:33], v9, s[36:39], s48 offen
  buffer_store_dwordx2 v[36:37], v9, s[36:39], s48 offen offset:2048
L_stend_27:
  s_mov_b64 exec, -1
  v_mov_b32 v9, 1
  v_mov_b32 v10, 128
  s_waitcnt vmcnt(0)
  s_mov_b64 exec, 1
  s_cmp_eq_u32 s43, 1
  s_cbranch_scc1 L_fast_28
  buffer_store_dword v9, v10, s[36:39], s76 offen sc1
  s_branch L_stend_29
L_fast_28:
  buffer_store_dword v9, v10, s[36:39], s76 offen
L_stend_29:
  s_mov_b64 exec, -1
  v_mov_b32 v44, 0x3f803f80
  v_mov_b32 v45, 0x3f803f80
  v_mov_b32 v46, 0x3f803f80
  v_mov_b32 v47, 0x3f803f80
  v_mov_b32 v112, 0
  v_mov_b32 v113, 0
  v_mov_b32 v114, 0
  v_mov_b32 v115, 0
  v_mov_b32 v116, 0
  v_mov_b32 v117, 0
  v_mov_b32 v118, 0
  v_mov_b32 v119, 0
  v_mov_b32 v120, 0
  v_mov_b32 v121, 0
  v_mov_b32 v122, 0
  v_mov_b32 v123, 0
  v_mov_b32 v16, 0
  v_mov_b32 v17, 0
  v_mov_b32 v18, 0
  v_mov_b32 v19, 0
  s_cmp_le_u32 s84, 8
  s_cbranch_scc1 L_fsl_31
L_fok_30:
  ds_read_b32 v125, v126
  ds_read_b64_tr_b16 a[0:1], v5 offset:49152
  ds_read_b64_tr_b16 a[2:3], v5 offset:49664
  ds_read_b64_tr_b16 a[4:5], v5 offset:49160
  ds_read_b64_tr_b16 a[6:7], v5 offset:49672
  ds_read_b64_tr_b16 a[8:9], v6 offset:49152
  ds_read_b64_tr_b16 a[10:11], v6 offset:49664
  ds_read_b64_tr_b16 a[12:13], v6 offset:49160
  ds_read_b64_tr_b16 a[14:15], v6 offset:49672
  s_waitcnt lgkmcnt(8)
  v_readfirstlane_b32 s84, v125
  s_nop 3
  s_cmp_le_u32 s84, 9
  s_cbranch_scc1 L_fsl_33
L_fok_32:
  ds_read_b32 v125, v126
  ds_read_b64_tr_b16 a[16:17], v15 offset:49152
  ds_read_b64_tr_b16 a[18:19], v15 offset:49664
  ds_read_b64_tr_b16 a[20:21], v15 offset:49160
  ds_read_b64_tr_b16 a[22:23], v15 offset:49672
  ds_read_b64_tr_b16 a[24:25], v124 offset:49152
  ds_read_b64_tr_b16 a[26:27], v124 offset:49664
  ds_read_b64_tr_b16 a[28:29], v124 offset:49160
  ds_read_b64_tr_b16 a[30:31], v124 offset:49672
  s_waitcnt lgkmcnt(9)
  v_mov_b32 v13, 9
  ds_write_b32 v126, v13 offset:16
  s_waitcnt lgkmcnt(9)
  v_readfirstlane_b32 s84, v125
  s_nop 3
  s_cmp_le_u32 s84, 10
  s_cbranch_scc1 L_fsl_35
L_fok_34:
  ds_read_b32 v125, v126
  ds_read_b64_tr_b16 a[32:33], v5 offset:0
  ds_read_b64_tr_b16 a[34:35], v5 offset:512
  ds_read_b64_tr_b16 a[36:37], v5 offset:8
  ds_read_b64_tr_b16 a[38:39], v5 offset:520
  ds_read_b64_tr_b16 a[40:41], v6 offset:0
  ds_read_b64_tr_b16 a[42:43], v6 offset:512
  ds_read_b64_tr_b16 a[44:45], v6 offset:8
  ds_read_b64_tr_b16 a[46:47], v6 offset:520
  s_waitcnt lgkmcnt(10)
  v_mov_b32 v13, 10
  ds_write_b32 v126, v13 offset:16
  s_waitcnt lgkmcnt(9)
  v_readfirstlane_b32 s84, v125
  s_nop 3
  s_cmp_le_u32 s84, 11
  s_cbranch_scc1 L_fsl_37
L_fok_36:
  ds_read_b32 v125, v126
  ds_read_b64_tr_b16 a[48:49], v5 offset:16384
  ds_read_b64_tr_b16 a[50:51], v5 offset:16896
  ds_read_b64_tr_b16 a[52:53], v5 offset:16392
  ds_read_b64_tr_b16 a[54:55], v5 offset:16904
  ds_read_b64_tr_b16 a[56:57], v6 offset:16384
  ds_read_b64_tr_b16 a[58:59], v6 offset:16896
  ds_read_b64_tr_b16 a[60:61], v6 offset:16392
  ds_read_b64_tr_b16 a[62:63], v6 offset:16904
  s_waitcnt lgkmcnt(10)
  v_mov_b32 v13, 11
  ds_write_b32 v126, v13 offset:16
  s_waitcnt lgkmcnt(9)
  v_readfirstlane_b32 s84, v125
  s_nop 3
  s_cmp_le_u32 s84, 12
  s_cbranch_scc1 L_fsl_39
L_fok_38:
  ds_read_b32 v125, v126
  ds_read_b64_tr_b16 a[64:65], v5 offset:32768
  ds_read_b64_tr_b16 a[66:67], v5 offset:33280
  ds_read_b64_tr_b16 a[68:69], v5 offset:32776
  ds_read_b64_tr_b16 a[70:71], v5 offset:33288
  ds_read_b64_tr_b16 a[72:73], v6 offset:32768
  ds_read_b64_tr_b16 a[74:75], v6 offset:33280
  ds_read_b64_tr_b16 a[76:77], v6 offset:32776
  ds_read_b64_tr_b16 a[78:79], v6 offset:33288
  s_waitcnt lgkmcnt(10)
  v_mov_b32 v13, 12
  ds_write_b32 v126, v13 offset:16
  s_lshl_b32 s48, s40, 9
  s_add_u32 s48, s48, 128
  v_lshlrev_b32 v10, 2, v1
  s_mov_b64 exec, 0xffffffff
L_poll_40:
  buffer_load_dword v9, v10, s[36:39], s48 offen sc1
  s_waitcnt vmcnt(0)
  v_cmp_eq_u32 vcc, 0, v9
  s_nop 3
  s_cmp_lg_u64 vcc, 0
  s_cbranch_scc1 L_poll_40
L_poll_40x:
  s_mov_b64 exec, -1
  s_add_u32 s48, s53, 4194304
  s_lshl_b32 s49, s42, 14
  s_add_u32 s48, s48, s49
  s_add_u32 s49, s49, 81920
  s_lshr_b32 s51, s40, 3
  s_lshl_b32 s51, s51, 2
  s_and_b32 s44, s40, 3
  s_add_u32 s51, s51, s44
  s_lshl_b32 s51, s51, 10
  s_add_u32 s44, s51, 0
  s_and_b32 s44, s44, 16383
  s_add_u32 s44, s44, s48
  s_add_u32 m0, s49, 0
  s_nop 0
  buffer_load_dwordx4 v4, s[36:39], s44 offen sc1 lds
  s_add_u32 s44, s51, 1024
  s_and_b32 s44, s44, 16383
  s_add_u32 s44, s44, s48
  s_add_u32 m0, s49, 1024
  s_nop 0
  buffer_load_dwordx4 v4, s[36:39], s44 offen sc1 lds
  s_add_u32 s44, s51, 2048
  s_and_b32 s44, s44, 16383
  s_add_u32 s44, s44, s48
  s_add_u32 m0, s49, 2048
  s_nop 0
  buffer_load_dwordx4 v4, s[36:39], s44 offen sc1 lds
  s_add_u32 s44, s51, 3072
  s_and_b32 s44, s44, 16383
  s_add_u32 s44, s44, s48
  s_add_u32 m0, s49, 3072
  s_nop 0
  buffer_load_dwordx4 v4, s[36:39], s44 offen sc1 lds
  s_add_u32 s44, s51, 4096
  s_and_b32 s44, s44, 16383
  s_add_u32 s44, s44, s48
  s_add_u32 m0, s49, 4096
  s_nop 0
  buffer_load_dwordx4 v4, s[36:39], s44 offen sc1 lds
  s_add_u32 s44, s51, 5120
  s_and_b32 s44, s44, 16383
  s_add_u32 s44, s44, s48
  s_add_u32 m0, s49, 5120
  s_nop 0
  buffer_load_dwordx4 v4, s[36:39], s44 offen sc1 lds
  s_add_u32 s44, s51, 6144
  s_and_b32 s44, s44, 16383
  s_add_u32 s44, s44, s48
  s_add_u32 m0, s49, 6144
  s_nop 0
  buffer_load_dwordx4 v4, s[36:39], s44 offen sc1 lds
  s_add_u32 s44, s51, 7168
  s_and_b32 s44, s44, 16383
  s_add_u32 s44, s44, s48
  s_add_u32 m0, s49, 7168
  s_nop 0
  buffer_load_dwordx4 v4, s[36:39], s44 offen sc1 lds
  s_add_u32 s44, s51, 8192
  s_and_b32 s44, s44, 16383
  s_add_u32 s44, s44, s48
  s_add_u32 m0, s49, 8192
  s_nop 0
  buffer_load_dwordx4 v4, s[36:39], s44 offen sc1 lds
  s_add_u32 s44, s51, 9216
  s_and_b32 s44, s44, 16383
  s_add_u32 s44, s44, s48
  s_add_u32 m0, s49, 9216
  s_nop 0
  buffer_load_dwordx4 v4, s[36:39], s44 offen sc1 lds
  s_add_u32 s44, s51, 10240
  s_and_b32 s44, s44, 16383
  s_add_u32 s44, s44, s48
  s_add_u32 m0, s49, 10240
  s_nop 0
  buffer_load_dwordx4 v4, s[36:39], s44 offen sc1 lds
  s_add_u32 s44, s51, 11264
  s_and_b32 s44, s44, 16383
  s_add_u32 s44, s44, s48
  s_add_u32 m0, s49, 11264
  s_nop 0
  buffer_load_dwordx4 v4, s[36:39], s44 offen sc1 lds
  s_add_u32 s44, s51, 12288
  s_and_b32 s44, s44, 16383
  s_add_u32 s44, s44, s48
  s_add_u32 m0, s49, 12288
  s_nop 0
  buffer_load_dwordx4 v4, s[36:39], s44 offen sc1 lds
  s_add_u32 s44, s51, 13312
  s_and_b32 s44, s44, 16383
  s_add_u32 s44, s44, s48
  s_add_u32 m0, s49, 13312
  s_nop 0
  buffer_load_dwordx4 v4, s[36:39], s44 offen sc1 lds
  s_add_u32 s44, s51, 14336
  s_and_b32 s44, s44, 16383
  s_add_u32 s44, s44, s48
  s_add_u32 m0, s49, 14336
  s_nop 0
  buffer_load_dwordx4 v4, s[36:39], s44 offen sc1 lds
  s_add_u32 s44, s51, 15360
  s_and_b32 s44, s44, 16383
  s_add_u32 s44, s44, s48
  s_add_u32 m0, s49, 15360
  s_nop 0
  buffer_load_dwordx4 v4, s[36:39], s44 offen sc1 lds
  v_lshrrev_b32 v9, 2, v1
  v_lshlrev_b32 v9, 7, v9
  v_and_b32 v10, 3, v1
  v_lshl_add_u32 v9, v10, 5, v9
  s_lshl_b32 s48, s40, 13
  s_lshl_b32 s49, s42, 11
  s_add_u32 s48, s48, s49
  s_add_u32 s48, s48, 7340032
  buffer_load_dwordx4 v[20:23], v9, s[36:39], s48 offen sc1
  buffer_load_dwordx4 v[24:27], v9, s[36:39], s48 offen offset:16 sc1
  s_waitcnt lgkmcnt(9)
  v_readfirstlane_b32 s84, v125
  s_nop 3
  s_cmp_le_u32 s84, 13
  s_cbranch_scc1 L_fsl_42
L_fok_41:
  ds_read_b32 v125, v126
  ds_read_b64_tr_b16 a[80:81], v5 offset:49152
  ds_read_b64_tr_b16 a[82:83], v5 offset:49664
  ds_read_b64_tr_b16 a[84:85], v5 offset:49160
  ds_read_b64_tr_b16 a[86:87], v5 offset:49672
  ds_read_b64_tr_b16 a[88:89], v6 offset:49152
  ds_read_b64_tr_b16 a[90:91], v6 offset:49664
  ds_read_b64_tr_b16 a[92:93], v6 offset:49160
  ds_read_b64_tr_b16 a[94:95], v6 offset:49672
  s_waitcnt lgkmcnt(10)
  v_mov_b32 v13, 13
  ds_write_b32 v126, v13 offset:16
  s_waitcnt lgkmcnt(9)
  v_readfirstlane_b32 s84, v125
  s_nop 3
  s_cmp_le_u32 s84, 14
  s_cbranch_scc1 L_fsl_44
L_fok_43:
  ds_read_b32 v125, v126
  ds_read_b64_tr_b16 a[96:97], v15 offset:49152
  ds_read_b64_tr_b16 a[98:99], v15 offset:49664
  ds_read_b64_tr_b16 a[100:101], v15 offset:49160
  ds_read_b64_tr_b16 a[102:103], v15 offset:49672
  ds_read_b64_tr_b16 a[104:105], v124 offset:49152
  ds_read_b64_tr_b16 a[106:107], v124 offset:49664
  ds_read_b64_tr_b16 a[108:109], v124 offset:49160
  ds_read_b64_tr_b16 a[110:111], v124 offset:49672
  s_waitcnt lgkmcnt(10)
  v_mov_b32 v13, 14
  ds_write_b32 v126, v13 offset:16
  s_waitcnt lgkmcnt(9)
  v_readfirstlane_b32 s84, v125
  s_nop 3
  s_cmp_le_u32 s84, 15
  s_cbranch_scc1 L_fsl_46
L_fok_45:
  ds_read_b32 v125, v126
  ds_read_b64_tr_b16 a[112:113], v5 offset:0
  ds_read_b64_tr_b16 a[114:115], v5 offset:512
  ds_read_b64_tr_b16 a[116:117], v5 offset:8
  ds_read_b64_tr_b16 a[118:119], v5 offset:520
  ds_read_b64_tr_b16 a[120:121], v6 offset:0
  ds_read_b64_tr_b16 a[122:123], v6 offset:512
  ds_read_b64_tr_b16 a[124:125], v6 offset:8
  ds_read_b64_tr_b16 a[126:127], v6 offset:520
  s_waitcnt lgkmcnt(10)
  v_mov_b32 v13, 15
  ds_write_b32 v126, v13 offset:16
  s_waitcnt lgkmcnt(1)
  v_mov_b32 v13, 16
  ds_write_b32 v126, v13 offset:16
  s_waitcnt lgkmcnt(0)
  v_mfma_f32_16x16x32_bf16 v[112:115], a[0:3], v[44:47], v[112:115]
  v_mfma_f32_16x16x32_bf16 v[116:119], a[4:7], v[44:47], v[116:119]
  v_mfma_f32_16x16x32_bf16 v[120:123], a[8:11], v[44:47], v[120:123]
  v_mfma_f32_16x16x32_bf16 v[16:19], a[12:15], v[44:47], v[16:19]
  v_mfma_f32_16x16x32_bf16 v[112:115], a[16:19], v[44:47], v[112:115]
  v_mfma_f32_16x16x32_bf16 v[116:119], a[20:23], v[44:47], v[116:119]
  v_mfma_f32_16x16x32_bf16 v[120:123], a[24:27], v[44:47], v[120:123]
  v_mfma_f32_16x16x32_bf16 v[16:19], a[28:31], v[44:47], v[16:19]
  v_mfma_f32_16x16x32_bf16 v[112:115], a[32:35], v[44:47], v[112:115]
  v_mfma_f32_16x16x32_bf16 v[116:119], a[36:39], v[44:47], v[116:119]
  v_mfma_f32_16x16x32_bf16 v[120:123], a[40:43], v[44:47], v[120:123]
  v_mfma_f32_16x16x32_bf16 v[16:19], a[44:47], v[44:47], v[16:19]
  v_mfma_f32_16x16x32_bf16 v[112:115], a[48:51], v[44:47], v[112:115]
  v_mfma_f32_16x16x32_bf16 v[116:119], a[52:55], v[44:47], v[116:119]
  v_mfma_f32_16x16x32_bf16 v[120:123], a[56:59], v[44:47], v[120:123]
  v_mfma_f32_16x16x32_bf16 v[16:19], a[60:63], v[44:47], v[16:19]
  v_mfma_f32_16x16x32_bf16 v[112:115], a[64:67], v[44:47], v[112:115]
  v_mfma_f32_16x16x32_bf16 v[116:119], a[68:71], v[44:47], v[116:119]
  v_mfma_f32_16x16x32_bf16 v[120:123], a[72:75], v[44:47], v[120:123]
  v_mfma_f32_16x16x32_bf16 v[16:19], a[76:79], v[44:47], v[16:19]
  v_mfma_f32_16x16x32_bf16 v[112:115], a[80:83], v[44:47], v[112:115]
  v_mfma_f32_16x16x32_bf16 v[116:119], a[84:87], v[44:47], v[116:119]
  v_mfma_f32_16x16x32_bf16 v[120:123], a[88:91], v[44:47], v[120:123]
  v_mfma_f32_16x16x32_bf16 v[16:19], a[92:95], v[44:47], v[16:19]
  v_mfma_f32_16x16x32_bf16 v[112:115], a[96:99], v[44:47], v[112:115]
  v_mfma_f32_16x16x32_bf16 v[116:119], a[100:103], v[44:47], v[116:119]
  v_mfma_f32_16x16x32_bf16 v[120:123], a[104:107], v[44:47], v[120:123]
  v_mfma_f32_16x16x32_bf16 v[16:19], a[108:111], v[44:47], v[16:19]
  v_mfma_f32_16x16x32_bf16 v[112:115], a[112:115], v[44:47], v[112:115]
  v_mfma_f32_16x16x32_bf16 v[116:119], a[116:119], v[44:47], v[116:119]
  v_mfma_f32_16x16x32_bf16 v[120:123], a[120:123], v[44:47], v[120:123]
  v_mfma_f32_16x16x32_bf16 v[16:19], a[124:127], v[44:47], v[16:19]
  s_waitcnt vmcnt(0)
  s_mov_b32 s48, 0x3b000000
  s_mov_b32 s49, 0x3727c5ac
  s_mov_b32 s50, 0x3fb8aa3b
  v_pk_add_f32 v[20:21], v[20:21], v[22:23]
  v_pk_add_f32 v[24:25], v[24:25], v[26:27]
  v_pk_add_f32 v[20:21], v[20:21], v[24:25]
  s_nop 1
  v_mov_b32_dpp v22, v20 quad_perm:[1,0,3,2] row_mask:0xf bank_mask:0xf
  v_mov_b32_dpp v23, v21 quad_perm:[1,0,3,2] row_mask:0xf bank_mask:0xf
  v_pk_add_f32 v[20:21], v[20:21], v[22:23]
  s_nop 1
  v_mov_b32_dpp v22, v20 quad_perm:[2,3,0,1] row_mask:0xf bank_mask:0xf
  v_mov_b32_dpp v23, v21 quad_perm:[2,3,0,1] row_mask:0xf bank_mask:0xf
  v_pk_add_f32 v[20:21], v[20:21], v[22:23]
  v_mul_f32 v20, s48, v20
  v_mul_f32 v21, s48, v21
  v_fma_f32 v21, -v20, v20, v21
  v_max_f32 v21, 0, v21
  v_add_f32 v21, s49, v21
  v_rsq_f32 v22, v21
  s_nop 0
  v_mul_f32 v22, s50, v22
  v_mul_f32_e64 v23, -v20, v22
  v_lshrrev_b32 v9, 2, v1
  v_lshlrev_b32 v9, 3, v9
  s_lshl_b32 s48, s42, 7
  s_add_u32 s48, s48, 148480
  v_add_u32 v9, s48, v9
  ds_write_b64 v9, v[22:23]
  s_waitcnt lgkmcnt(0)
  v_mov_b32 v9, 1
  s_mov_b64 exec, 1
  ds_add_u32 v8, v9 offset:44
  s_mov_b64 exec, -1
L_spin_47:
  ds_read_b32 v9, v8 offset:44
  s_waitcnt lgkmcnt(0)
  v_readfirstlane_b32 s50, v9
  s_nop 3
  s_cmp_lt_u32 s50, 4
  s_cbranch_scc1 L_spin_47
L_spin_47x:
  ds_read_b128 v[20:23], v14 offset:0
  ds_read_b128 v[24:27], v14 offset:16384
  ds_read_b128 v[28:31], v14 offset:32768
  ds_read_b128 v[32:35], v14 offset:49152
  ds_read_b128 v[36:39], v14 offset:1024
  s_waitcnt lgkmcnt(4)
  v_mfma_f32_16x16x32_bf16 v[48:51], a[0:3], v[20:23], 0
  ds_read_b128 v[40:43], v14 offset:17408
  ds_read_b32 v125, v126
  v_mfma_f32_16x16x32_bf16 v[52:55], a[4:7], v[20:23], 0
  v_mfma_f32_16x16x32_bf16 v[56:59], a[8:11], v[20:23], 0
  v_mfma_f32_16x16x32_bf16 v[60:63], a[12:15], v[20:23], 0
  s_waitcnt lgkmcnt(5)
  v_mfma_f32_16x16x32_bf16 v[64:67], a[0:3], v[24:27], 0
  ds_read_b128 v[20:23], v14 offset:33792
  v_mfma_f32_16x16x32_bf16 v[68:71], a[4:7], v[24:27], 0
  v_mfma_f32_16x16x32_bf16 v[72:75], a[8:11], v[24:27], 0
  v_mfma_f32_16x16x32_bf16 v[76:79], a[12:15], v[24:27], 0
  s_waitcnt lgkmcnt(5)
  v_mfma_f32_16x16x32_bf16 v[80:83], a[0:3], v[28:31], 0
  ds_read_b128 v[24:27], v14 offset:50176
  v_mfma_f32_16x16x32_bf16 v[84:87], a[4:7], v[28:31], 0
  v_mfma_f32_16x16x32_bf16 v[88:91], a[8:11], v[28:31], 0
  v_mfma_f32_16x16x32_bf16 v[92:95], a[12:15], v[28:31], 0
  s_waitcnt lgkmcnt(5)
  v_mfma_f32_16x16x32_bf16 v[96:99], a[0:3], v[32:35], 0
  ds_read_b128 v[28:31], v14 offset:2048
  v_mfma_f32_16x16x32_bf16 v[100:103], a[4:7], v[32:35], 0
  v_mfma_f32_16x16x32_bf16 v[104:107], a[8:11], v[32:35], 0
  v_mfma_f32_16x16x32_bf16 v[108:111], a[12:15], v[32:35], 0
  s_waitcnt lgkmcnt(5)
  v_mfma_f32_16x16x32_bf16 v[48:51], a[16:19], v[36:39], v[48:51]
  ds_read_b128 v[32:35], v14 offset:18432
  s_waitcnt lgkmcnt(4)
  v_readfirstlane_b32 s84, v125
  v_mfma_f32_16x16x32_bf16 v[52:55], a[20:23], v[36:39], v[52:55]
  s_nop 2
  s_cmp_le_u32 s84, 16
  s_cbranch_scc1 L_fsl_49
L_fok_48:
  v_mfma_f32_16x16x32_bf16 v[56:59], a[24:27], v[36:39], v[56:59]
  ds_read_b64_tr_b16 a[0:1], v5 offset:16384
  v_mfma_f32_16x16x32_bf16 v[60:63], a[28:31], v[36:39], v[60:63]
  v_mfma_f32_16x16x32_bf16 v[64:67], a[16:19], v[40:43], v[64:67]
  ds_read_b128 v[36:39], v14 offset:34816
  ds_read_b64_tr_b16 a[2:3], v5 offset:16896
  v_mfma_f32_16x16x32_bf16 v[68:71], a[20:23], v[40:43], v[68:71]
  ds_read_b64_tr_b16 a[4:5], v5 offset:16392
  v_mfma_f32_16x16x32_bf16 v[72:75], a[24:27], v[40:43], v[72:75]
  v_mfma_f32_16x16x32_bf16 v[76:79], a[28:31], v[40:43], v[76:79]
  ds_read_b64_tr_b16 a[6:7], v5 offset:16904
  s_waitcnt lgkmcnt(8)
  v_mfma_f32_16x16x32_bf16 v[80:83], a[16:19], v[20:23], v[80:83]
  ds_read_b128 v[40:43], v14 offset:51200
  ds_read_b64_tr_b16 a[8:9], v6 offset:16384
  v_mfma_f32_16x16x32_bf16 v[84:87], a[20:23], v[20:23], v[84:87]
  v_mfma_f32_16x16x32_bf16 v[88:91], a[24:27], v[20:23], v[88:91]
  ds_read_b64_tr_b16 a[10:11], v6 offset:16896
  v_mfma_f32_16x16x32_bf16 v[92:95], a[28:31], v[20:23], v[92:95]
  ds_read_b64_tr_b16 a[12:13], v6 offset:16392
  s_waitcnt lgkmcnt(11)
  v_mfma_f32_16x16x32_bf16 v[96:99], a[16:19], v[24:27], v[96:99]
  ds_read_b128 v[20:23], v14 offset:3072
  v_mfma_f32_16x16x32_bf16 v[100:103], a[20:23], v[24:27], v[100:103]
  ds_read_b64_tr_b16 a[14:15], v6 offset:16904
  v_mfma_f32_16x16x32_bf16 v[104:107], a[24:27], v[24:27], v[104:107]
  ds_read_b32 v125, v126
  v_mfma_f32_16x16x32_bf16 v[108:111], a[28:31], v[24:27], v[108:111]
  s_waitcnt lgkmcnt(13)
  v_mfma_f32_16x16x32_bf16 v[48:51], a[32:35], v[28:31], v[48:51]
  ds_read_b128 v[24:27], v14 offset:19456
  s_waitcnt lgkmcnt(2)
  v_mov_b32 v13, 17
  ds_write_b32 v126, v13 offset:16
  v_mfma_f32_16x16x32_bf16 v[52:55], a[36:39], v[28:31], v[52:55]
  s_waitcnt lgkmcnt(2)
  v_readfirstlane_b32 s84, v125
  v_mfma_f32_16x16x32_bf16 v[56:59], a[40:43], v[28:31], v[56:59]
  s_nop 2
  s_cmp_le_u32 s84, 17
  s_cbranch_scc1 L_fsl_51
L_fok_50:
  v_mfma_f32_16x16x32_bf16 v[60:63], a[44:47], v[28:31], v[60:63]
  v_mfma_f32_16x16x32_bf16 v[64:67], a[32:35], v[32:35], v[64:67]
  ds_read_b128 v[28:31], v14 offset:35840
  ds_read_b64_tr_b16 a[16:17], v5 offset:32768
  v_mfma_f32_16x16x32_bf16 v[68:71], a[36:39], v[32:35], v[68:71]
  ds_read_b64_tr_b16 a[18:19], v5 offset:33280
  v_mfma_f32_16x16x32_bf16 v[72:75], a[40:43], v[32:35], v[72:75]
  ds_read_b64_tr_b16 a[20:21], v5 offset:32776
  v_mfma_f32_16x16x32_bf16 v[76:79], a[44:47], v[32:35], v[76:79]
  v_mfma_f32_16x16x32_bf16 v[80:83], a[32:35], v[36:39], v[80:83]
  ds_read_b128 v[32:35], v14 offset:52224
  ds_read_b64_tr_b16 a[22:23], v5 offset:33288
  v_mfma_f32_16x16x32_bf16 v[84:87], a[36:39], v[36:39], v[84:87]
  ds_read_b64_tr_b16 a[24:25], v6 offset:32768
  v_mfma_f32_16x16x32_bf16 v[88:91], a[40:43], v[36:39], v[88:91]
  ds_read_b64_tr_b16 a[26:27], v6 offset:33280
  v_mfma_f32_16x16x32_bf16 v[92:95], a[44:47], v[36:39], v[92:95]
  v_mfma_f32_16x16x32_bf16 v[96:99], a[32:35], v[40:43], v[96:99]
  ds_read_b128 v[36:39], v14 offset:4096
  ds_read_b64_tr_b16 a[28:29], v6 offset:32776
  v_mfma_f32_16x16x32_bf16 v[100:103], a[36:39], v[40:43], v[100:103]
  ds_read_b64_tr_b16 a[30:31], v6 offset:33288
  v_mfma_f32_16x16x32_bf16 v[104:107], a[40:43], v[40:43], v[104:107]
  ds_read_b32 v125, v126
  v_mfma_f32_16x16x32_bf16 v[108:111], a[44:47], v[40:43], v[108:111]
  v_mfma_f32_16x16x32_bf16 v[48:51], a[48:51], v[20:23], v[48:51]
  ds_read_b128 v[40:43], v14 offset:20480
  s_waitcnt lgkmcnt(2)
  v_mov_b32 v13, 18
  ds_write_b32 v126, v13 offset:16
  v_mfma_f32_16x16x32_bf16 v[52:55], a[52:55], v[20:23], v[52:55]
  s_waitcnt lgkmcnt(2)
  v_readfirstlane_b32 s84, v125
  v_mfma_f32_16x16x32_bf16 v[56:59], a[56:59], v[20:23], v[56:59]
  s_nop 2
  s_cmp_le_u32 s84, 18
  s_cbranch_scc1 L_fsl_53
L_fok_52:
  v_mfma_f32_16x16x32_bf16 v[60:63], a[60:63], v[20:23], v[60:63]
  v_mfma_f32_16x16x32_bf16 v[64:67], a[48:51], v[24:27], v[64:67]
  ds_read_b128 v[20:23], v14 offset:36864
  ds_read_b64_tr_b16 a[32:33], v5 offset:49152
  v_mfma_f32_16x16x32_bf16 v[68:71], a[52:55], v[24:27], v[68:71]
  ds_read_b64_tr_b16 a[34:35], v5 offset:49664
  v_mfma_f32_16x16x32_bf16 v[72:75], a[56:59], v[24:27], v[72:75]
  ds_read_b64_tr_b16 a[36:37], v5 offset:49160
  v_mfma_f32_16x16x32_bf16 v[76:79], a[60:63], v[24:27], v[76:79]
  v_mfma_f32_16x16x32_bf16 v[80:83], a[48:51], v[28:31], v[80:83]
  ds_read_b128 v[24:27], v14 offset:53248
  ds_read_b64_tr_b16 a[38:39], v5 offset:49672
  v_mfma_f32_16x16x32_bf16 v[84:87], a[52:55], v[28:31], v[84:87]
  ds_read_b64_tr_b16 a[40:41], v6 offset:49152
  v_mfma_f32_16x16x32_bf16 v[88:91], a[56:59], v[28:31], v[88:91]
  ds_read_b64_tr_b16 a[42:43], v6 offset:49664
  v_mfma_f32_16x16x32_bf16 v[92:95], a[60:63], v[28:31], v[92:95]
  v_mfma_f32_16x16x32_bf16 v[96:99], a[48:51], v[32:35], v[96:99]
  ds_read_b128 v[28:31], v14 offset:5120
  ds_read_b64_tr_b16 a[44:45], v6 offset:49160
  v_mfma_f32_16x16x32_bf16 v[100:103], a[52:55], v[32:35], v[100:103]
  ds_read_b64_tr_b16 a[46:47], v6 offset:49672
  v_mfma_f32_16x16x32_bf16 v[104:107], a[56:59], v[32:35], v[104:107]
  ds_read_b32 v125, v126
  v_mfma_f32_16x16x32_bf16 v[108:111], a[60:63], v[32:35], v[108:111]
  v_mfma_f32_16x16x32_bf16 v[48:51], a[64:67], v[36:39], v[48:51]
  ds_read_b128 v[32:35], v14 offset:21504
  s_waitcnt lgkmcnt(2)
  v_mov_b32 v13, 19
  ds_write_b32 v126, v13 offset:16
  v_mfma_f32_16x16x32_bf16 v[52:55], a[68:71], v[36:39], v[52:55]
  s_waitcnt lgkmcnt(2)
  v_readfirstlane_b32 s84, v125
  v_mfma_f32_16x16x32_bf16 v[56:59], a[72:75], v[36:39], v[56:59]
  s_nop 2
  s_cmp_le_u32 s84, 19
  s_cbranch_scc1 L_fsl_55
L_fok_54:
  v_mfma_f32_16x16x32_bf16 v[60:63], a[76:79], v[36:39], v[60:63]
  v_mfma_f32_16x16x32_bf16 v[64:67], a[64:67], v[40:43], v[64:67]
  ds_read_b128 v[36:39], v14 offset:37888
  ds_read_b64_tr_b16 a[48:49], v15 offset:49152
  v_mfma_f32_16x16x32_bf16 v[68:71], a[68:71], v[40:43], v[68:71]
  ds_read_b64_tr_b16 a[50:51], v15 offset:49664
  v_mfma_f32_16x16x32_bf16 v[72:75], a[72:75], v[40:43], v[72:75]
  ds_read_b64_tr_b16 a[52:53], v15 offset:49160
  v_mfma_f32_16x16x32_bf16 v[76:79], a[76:79], v[40:43], v[76:79]
  v_mfma_f32_16x16x32_bf16 v[80:83], a[64:67], v[20:23], v[80:83]
  ds_read_b128 v[40:43], v14 offset:54272
  ds_read_b64_tr_b16 a[54:55], v15 offset:49672
  v_mfma_f32_16x16x32_bf16 v[84:87], a[68:71], v[20:23], v[84:87]
  ds_read_b64_tr_b16 a[56:57], v124 offset:49152
  v_mfma_f32_16x16x32_bf16 v[88:91], a[72:75], v[20:23], v[88:91]
  ds_read_b64_tr_b16 a[58:59], v124 offset:49664
  v_mfma_f32_16x16x32_bf16 v[92:95], a[76:79], v[20:23], v[92:95]
  v_mfma_f32_16x16x32_bf16 v[96:99], a[64:67], v[24:27], v[96:99]
  ds_read_b128 v[20:23], v14 offset:6144
  ds_read_b64_tr_b16 a[60:61], v124 offset:49160
  v_mfma_f32_16x16x32_bf16 v[100:103], a[68:71], v[24:27], v[100:103]
  ds_read_b64_tr_b16 a[62:63], v124 offset:49672
  v_mfma_f32_16x16x32_bf16 v[104:107], a[72:75], v[24:27], v[104:107]
  ds_read_b32 v125, v126
  v_mfma_f32_16x16x32_bf16 v[108:111], a[76:79], v[24:27], v[108:111]
  v_mfma_f32_16x16x32_bf16 v[48:51], a[80:83], v[28:31], v[48:51]
  ds_read_b128 v[24:27], v14 offset:22528
  s_waitcnt lgkmcnt(2)
  v_mov_b32 v13, 20
  ds_write_b32 v126, v13 offset:16
  v_mfma_f32_16x16x32_bf16 v[52:55], a[84:87], v[28:31], v[52:55]
  s_waitcnt lgkmcnt(2)
  v_readfirstlane_b32 s84, v125
  v_mfma_f32_16x16x32_bf16 v[56:59], a[88:91], v[28:31], v[56:59]
  s_nop 2
  s_cmp_le_u32 s84, 20
  s_cbranch_scc1 L_fsl_57
L_fok_56:
  v_mfma_f32_16x16x32_bf16 v[60:63], a[92:95], v[28:31], v[60:63]
  v_mfma_f32_16x16x32_bf16 v[64:67], a[80:83], v[32:35], v[64:67]
  ds_read_b128 v[28:31], v14 offset:38912
  ds_read_b64_tr_b16 a[64:65], v5 offset:0
  v_mfma_f32_16x16x32_bf16 v[68:71], a[84:87], v[32:35], v[68:71]
  ds_read_b64_tr_b16 a[66:67], v5 offset:512
  v_mfma_f32_16x16x32_bf16 v[72:75], a[88:91], v[32:35], v[72:75]
  ds_read_b64_tr_b16 a[68:69], v5 offset:8
  v_mfma_f32_16x16x32_bf16 v[76:79], a[92:95], v[32:35], v[76:79]
  v_mfma_f32_16x16x32_bf16 v[80:83], a[80:83], v[36:39], v[80:83]
  ds_read_b128 v[32:35], v14 offset:55296
  ds_read_b64_tr_b16 a[70:71], v5 offset:520
  v_mfma_f32_16x16x32_bf16 v[84:87], a[84:87], v[36:39], v[84:87]
  ds_read_b64_tr_b16 a[72:73], v6 offset:0
  v_mfma_f32_16x16x32_bf16 v[88:91], a[88:91], v[36:39], v[88:91]
  ds_read_b64_tr_b16 a[74:75], v6 offset:512
  v_mfma_f32_16x16x32_bf16 v[92:95], a[92:95], v[36:39], v[92:95]
  v_mfma_f32_16x16x32_bf16 v[96:99], a[80:83], v[40:43], v[96:99]
  ds_read_b128 v[36:39], v14 offset:7168
  ds_read_b64_tr_b16 a[76:77], v6 offset:8
  v_mfma_f32_16x16x32_bf16 v[100:103], a[84:87], v[40:43], v[100:103]
  ds_read_b64_tr_b16 a[78:79], v6 offset:520
  v_mfma_f32_16x16x32_bf16 v[104:107], a[88:91], v[40:43], v[104:107]
  ds_read_b32 v125, v126
  v_mfma_f32_16x16x32_bf16 v[108:111], a[92:95], v[40:43], v[108:111]
  v_mfma_f32_16x16x32_bf16 v[48:51], a[96:99], v[20:23], v[48:51]
  ds_read_b128 v[40:43], v14 offset:23552
  s_waitcnt lgkmcnt(2)
  v_mov_b32 v13, 21
  ds_write_b32 v126, v13 offset:16
  v_mfma_f32_16x16x32_bf16 v[52:55], a[100:103], v[20:23], v[52:55]
  s_waitcnt lgkmcnt(2)
  v_readfirstlane_b32 s84, v125
  v_mfma_f32_16x16x32_bf16 v[56:59], a[104:107], v[20:23], v[56:59]
  s_nop 2
  s_cmp_le_u32 s84, 21
  s_cbranch_scc1 L_fsl_59
L_fok_58:
  v_mfma_f32_16x16x32_bf16 v[60:63], a[108:111], v[20:23], v[60:63]
  v_mfma_f32_16x16x32_bf16 v[64:67], a[96:99], v[24:27], v[64:67]
  ds_read_b128 v[20:23], v14 offset:39936
  ds_read_b64_tr_b16 a[80:81], v5 offset:16384
  v_mfma_f32_16x16x32_bf16 v[68:71], a[100:103], v[24:27], v[68:71]
  ds_read_b64_tr_b16 a[82:83], v5 offset:16896
  v_mfma_f32_16x16x32_bf16 v[72:75], a[104:107], v[24:27], v[72:75]
  ds_read_b64_tr_b16 a[84:85], v5 offset:16392
  v_mfma_f32_16x16x32_bf16 v[76:79], a[108:111], v[24:27], v[76:79]
  v_mfma_f32_16x16x32_bf16 v[80:83], a[96:99], v[28:31], v[80:83]
  ds_read_b128 v[24:27], v14 offset:56320
  ds_read_b64_tr_b16 a[86:87], v5 offset:16904
  v_mfma_f32_16x16x32_bf16 v[84:87], a[100:103], v[28:31], v[84:87]
  ds_read_b64_tr_b16 a[88:89], v6 offset:16384
  v_mfma_f32_16x16x32_bf16 v[88:91], a[104:107], v[28:31], v[88:91]
  ds_read_b64_tr_b16 a[90:91], v6 offset:16896
  v_mfma_f32_16x16x32_bf16 v[92:95], a[108:111], v[28:31], v[92:95]
  v_mfma_f32_16x16x32_bf16 v[96:99], a[96:99], v[32:35], v[96:99]
  ds_read_b128 v[28:31], v14 offset:8192
  ds_read_b64_tr_b16 a[92:93], v6 offset:16392
  v_mfma_f32_16x16x32_bf16 v[100:103], a[100:103], v[32:35], v[100:103]
  ds_read_b64_tr_b16 a[94:95], v6 offset:16904
  v_mfma_f32_16x16x32_bf16 v[104:107], a[104:107], v[32:35], v[104:107]
  ds_read_b32 v125, v126
  v_mfma_f32_16x16x32_bf16 v[108:111], a[108:111], v[32:35], v[108:111]
  v_mfma_f32_16x16x32_bf16 v[48:51], a[112:115], v[36:39], v[48:51]
  ds_read_b128 v[32:35], v14 offset:24576
  s_waitcnt lgkmcnt(2)
  v_mov_b32 v13, 22
  ds_write_b32 v126, v13 offset:16
  v_mfma_f32_16x16x32_bf16 v[52:55], a[116:119], v[36:39], v[52:55]
  s_waitcnt lgkmcnt(2)
  v_readfirstlane_b32 s84, v125
  v_mfma_f32_16x16x32_bf16 v[56:59], a[120:123], v[36:39], v[56:59]
  s_nop 2
  s_cmp_le_u32 s84, 22
  s_cbranch_scc1 L_fsl_61
L_fok_60:
  v_mfma_f32_16x16x32_bf16 v[60:63], a[124:127], v[36:39], v[60:63]
  v_mfma_f32_16x16x32_bf16 v[64:67], a[112:115], v[40:43], v[64:67]
  ds_read_b128 v[36:39], v14 offset:40960
  ds_read_b64_tr_b16 a[96:97], v5 offset:32768
  v_mfma_f32_16x16x32_bf16 v[68:71], a[116:119], v[40:43], v[68:71]
  ds_read_b64_tr_b16 a[98:99], v5 offset:33280
  v_mfma_f32_16x16x32_bf16 v[72:75], a[120:123], v[40:43], v[72:75]
  ds_read_b64_tr_b16 a[100:101], v5 offset:32776
  v_mfma_f32_16x16x32_bf16 v[76:79], a[124:127], v[40:43], v[76:79]
  v_mfma_f32_16x16x32_bf16 v[80:83], a[112:115], v[20:23], v[80:83]
  ds_read_b128 v[40:43], v14 offset:57344
  ds_read_b64_tr_b16 a[102:103], v5 offset:33288
  v_mfma_f32_16x16x32_bf16 v[84:87], a[116:119], v[20:23], v[84:87]
  ds_read_b64_tr_b16 a[104:105], v6 offset:32768
  v_mfma_f32_16x16x32_bf16 v[88:91], a[120:123], v[20:23], v[88:91]
  ds_read_b64_tr_b16 a[106:107], v6 offset:33280
  v_mfma_f32_16x16x32_bf16 v[92:95], a[124:127], v[20:23], v[92:95]
  v_mfma_f32_16x16x32_bf16 v[96:99], a[112:115], v[24:27], v[96:99]
  ds_read_b128 v[20:23], v14 offset:9216
  ds_read_b64_tr_b16 a[108:109], v6 offset:32776
  v_mfma_f32_16x16x32_bf16 v[100:103], a[116:119], v[24:27], v[100:103]
  ds_read_b64_tr_b16 a[110:111], v6 offset:33288
  v_mfma_f32_16x16x32_bf16 v[104:107], a[120:123], v[24:27], v[104:107]
  ds_read_b32 v125, v126
  v_mfma_f32_16x16x32_bf16 v[108:111], a[124:127], v[24:27], v[108:111]
  v_mfma_f32_16x16x32_bf16 v[48:51], a[0:3], v[28:31], v[48:51]
  ds_read_b128 v[24:27], v14 offset:25600
  v_mfma_f32_16x16x32_bf16 v[112:115], a[0:3], v[44:47], v[112:115]
  v_mfma_f32_16x16x32_bf16 v[52:55], a[4:7], v[28:31], v[52:55]
  v_mfma_f32_16x16x32_bf16 v[116:119], a[4:7], v[44:47], v[116:119]
  v_mfma_f32_16x16x32_bf16 v[56:59], a[8:11], v[28:31], v[56:59]
  v_mfma_f32_16x16x32_bf16 v[120:123], a[8:11], v[44:47], v[120:123]
  v_mfma_f32_16x16x32_bf16 v[60:63], a[12:15], v[28:31], v[60:63]
  v_mfma_f32_16x16x32_bf16 v[16:19], a[12:15], v[44:47], v[16:19]
  s_waitcnt lgkmcnt(14)
  v_mfma_f32_16x16x32_bf16 v[64:67], a[0:3], v[32:35], v[64:67]
  ds_read_b128 v[28:31], v14 offset:41984
  s_waitcnt lgkmcnt(3)
  v_mov_b32 v13, 23
  ds_write_b32 v126, v13 offset:16
  v_mfma_f32_16x16x32_bf16 v[68:71], a[4:7], v[32:35], v[68:71]
  s_waitcnt lgkmcnt(3)
  v_readfirstlane_b32 s84, v125
  v_mfma_f32_16x16x32_bf16 v[72:75], a[8:11], v[32:35], v[72:75]
  s_nop 2
  s_cmp_le_u32 s84, 23
  s_cbranch_scc1 L_fsl_63
L_fok_62:
  v_mfma_f32_16x16x32_bf16 v[76:79], a[12:15], v[32:35], v[76:79]
  ds_read_b64_tr_b16 a[112:113], v5 offset:49152
  v_mfma_f32_16x16x32_bf16 v[80:83], a[0:3], v[36:39], v[80:83]
  ds_read_b128 v[32:35], v14 offset:58368
  ds_read_b64_tr_b16 a[114:115], v5 offset:49664
  v_mfma_f32_16x16x32_bf16 v[84:87], a[4:7], v[36:39], v[84:87]
  ds_read_b64_tr_b16 a[116:117], v5 offset:49160
  v_mfma_f32_16x16x32_bf16 v[88:91], a[8:11], v[36:39], v[88:91]
  ds_read_b64_tr_b16 a[118:119], v5 offset:49672
  v_mfma_f32_16x16x32_bf16 v[92:95], a[12:15], v[36:39], v[92:95]
  ds_read_b64_tr_b16 a[120:121], v6 offset:49152
  v_mfma_f32_16x16x32_bf16 v[96:99], a[0:3], v[40:43], v[96:99]
  ds_read_b128 v[36:39], v14 offset:10240
  ds_read_b64_tr_b16 a[122:123], v6 offset:49664
  v_mfma_f32_16x16x32_bf16 v[100:103], a[4:7], v[40:43], v[100:103]
  ds_read_b64_tr_b16 a[124:125], v6 offset:49160
  v_mfma_f32_16x16x32_bf16 v[104:107], a[8:11], v[40:43], v[104:107]
  ds_read_b64_tr_b16 a[126:127], v6 offset:49672
  v_mfma_f32_16x16x32_bf16 v[108:111], a[12:15], v[40:43], v[108:111]
  ds_read_b32 v125, v126
  v_mfma_f32_16x16x32_bf16 v[48:51], a[16:19], v[20:23], v[48:51]
  ds_read_b128 v[40:43], v14 offset:26624
  v_mfma_f32_16x16x32_bf16 v[112:115], a[16:19], v[44:47], v[112:115]
  v_mfma_f32_16x16x32_bf16 v[52:55], a[20:23], v[20:23], v[52:55]
  v_mfma_f32_16x16x32_bf16 v[116:119], a[20:23], v[44:47], v[116:119]
  v_mfma_f32_16x16x32_bf16 v[56:59], a[24:27], v[20:23], v[56:59]
  v_mfma_f32_16x16x32_bf16 v[120:123], a[24:27], v[44:47], v[120:123]
  v_mfma_f32_16x16x32_bf16 v[60:63], a[28:31], v[20:23], v[60:63]
  v_mfma_f32_16x16x32_bf16 v[16:19], a[28:31], v[44:47], v[16:19]
  s_waitcnt lgkmcnt(14)
  v_mfma_f32_16x16x32_bf16 v[64:67], a[16:19], v[24:27], v[64:67]
  ds_read_b128 v[20:23], v14 offset:43008
  s_waitcnt lgkmcnt(3)
  v_mov_b32 v13, 24
  ds_write_b32 v126, v13 offset:16
  v_mfma_f32_16x16x32_bf16 v[68:71], a[20:23], v[24:27], v[68:71]
  s_waitcnt lgkmcnt(3)
  v_readfirstlane_b32 s84, v125
  v_mfma_f32_16x16x32_bf16 v[72:75], a[24:27], v[24:27], v[72:75]
  s_nop 2
  s_cmp_le_u32 s84, 24
  s_cbranch_scc1 L_fsl_65
L_fok_64:
  v_mfma_f32_16x16x32_bf16 v[76:79], a[28:31], v[24:27], v[76:79]
  ds_read_b64_tr_b16 a[0:1], v15 offset:49152
  v_mfma_f32_16x16x32_bf16 v[80:83], a[16:19], v[28:31], v[80:83]
  ds_read_b128 v[24:27], v14 offset:59392
  ds_read_b64_tr_b16 a[2:3], v15 offset:49664
  v_mfma_f32_16x16x32_bf16 v[84:87], a[20:23], v[28:31], v[84:87]
  ds_read_b64_tr_b16 a[4:5], v15 offset:49160
  v_mfma_f32_16x16x32_bf16 v[88:91], a[24:27], v[28:31], v[88:91]
  ds_read_b64_tr_b16 a[6:7], v15 offset:49672
  v_mfma_f32_16x16x32_bf16 v[92:95], a[28:31], v[28:31], v[92:95]
  ds_read_b64_tr_b16 a[8:9], v124 offset:49152
  v_mfma_f32_16x16x32_bf16 v[96:99], a[16:19], v[32:35], v[96:99]
  ds_read_b128 v[28:31], v14 offset:11264
  ds_read_b64_tr_b16 a[10:11], v124 offset:49664
  v_mfma_f32_16x16x32_bf16 v[100:103], a[20:23], v[32:35], v[100:103]
  ds_read_b64_tr_b16 a[12:13], v124 offset:49160
  v_mfma_f32_16x16x32_bf16 v[104:107], a[24:27], v[32:35], v[104:107]
  ds_read_b64_tr_b16 a[14:15], v124 offset:49672
  v_mfma_f32_16x16x32_bf16 v[108:111], a[28:31], v[32:35], v[108:111]
  ds_read_b32 v125, v126
  v_mfma_f32_16x16x32_bf16 v[48:51], a[32:35], v[36:39], v[48:51]
  ds_read_b128 v[32:35], v14 offset:27648
  v_mfma_f32_16x16x32_bf16 v[112:115], a[32:35], v[44:47], v[112:115]
  v_mfma_f32_16x16x32_bf16 v[52:55], a[36:39], v[36:39], v[52:55]
  v_mfma_f32_16x16x32_bf16 v[116:119], a[36:39], v[44:47], v[116:119]
  v_mfma_f32_16x16x32_bf16 v[56:59], a[40:43], v[36:39], v[56:59]
  v_mfma_f32_16x16x32_bf16 v[120:123], a[40:43], v[44:47], v[120:123]
  v_mfma_f32_16x16x32_bf16 v[60:63], a[44:47], v[36:39], v[60:63]
  v_mfma_f32_16x16x32_bf16 v[16:19], a[44:47], v[44:47], v[16:19]
  s_waitcnt lgkmcnt(14)
  v_mfma_f32_16x16x32_bf16 v[64:67], a[32:35], v[40:43], v[64:67]
  ds_read_b128 v[36:39], v14 offset:44032
  s_waitcnt lgkmcnt(3)
  v_mov_b32 v13, 25
  ds_write_b32 v126, v13 offset:16
  v_mfma_f32_16x16x32_bf16 v[68:71], a[36:39], v[40:43], v[68:71]
  s_waitcnt lgkmcnt(3)
  v_readfirstlane_b32 s84, v125
  v_mfma_f32_16x16x32_bf16 v[72:75], a[40:43], v[40:43], v[72:75]
  s_nop 2
  s_cmp_le_u32 s84, 25
  s_cbranch_scc1 L_fsl_67
L_fok_66:
  v_mfma_f32_16x16x32_bf16 v[76:79], a[44:47], v[40:43], v[76:79]
  ds_read_b64_tr_b16 a[16:17], v5 offset:0
  v_mfma_f32_16x16x32_bf16 v[80:83], a[32:35], v[20:23], v[80:83]
  ds_read_b128 v[40:43], v14 offset:60416
  ds_read_b64_tr_b16 a[18:19], v5 offset:512
  v_mfma_f32_16x16x32_bf16 v[84:87], a[36:39], v[20:23], v[84:87]
  ds_read_b64_tr_b16 a[20:21], v5 offset:8
  v_mfma_f32_16x16x32_bf16 v[88:91], a[40:43], v[20:23], v[88:91]
  ds_read_b64_tr_b16 a[22:23], v5 offset:520
  v_mfma_f32_16x16x32_bf16 v[92:95], a[44:47], v[20:23], v[92:95]
  ds_read_b64_tr_b16 a[24:25], v6 offset:0
  v_mfma_f32_16x16x32_bf16 v[96:99], a[32:35], v[24:27], v[96:99]
  ds_read_b128 v[20:23], v14 offset:12288
  ds_read_b64_tr_b16 a[26:27], v6 offset:512
  v_mfma_f32_16x16x32_bf16 v[100:103], a[36:39], v[24:27], v[100:103]
  ds_read_b64_tr_b16 a[28:29], v6 offset:8
  v_mfma_f32_16x16x32_bf16 v[104:107], a[40:43], v[24:27], v[104:107]
  ds_read_b64_tr_b16 a[30:31], v6 offset:520
  v_mfma_f32_16x16x32_bf16 v[108:111], a[44:47], v[24:27], v[108:111]
  ds_read_b32 v125, v126
  v_mfma_f32_16x16x32_bf16 v[48:51], a[48:51], v[28:31], v[48:51]
  ds_read_b128 v[24:27], v14 offset:28672
  v_mfma_f32_16x16x32_bf16 v[112:115], a[48:51], v[44:47], v[112:115]
  v_mfma_f32_16x16x32_bf16 v[52:55], a[52:55], v[28:31], v[52:55]
  v_mfma_f32_16x16x32_bf16 v[116:119], a[52:55], v[44:47], v[116:119]
  v_mfma_f32_16x16x32_bf16 v[56:59], a[56:59], v[28:31], v[56:59]
  v_mfma_f32_16x16x32_bf16 v[120:123], a[56:59], v[44:47], v[120:123]
  v_mfma_f32_16x16x32_bf16 v[60:63], a[60:63], v[28:31], v[60:63]
  v_mfma_f32_16x16x32_bf16 v[16:19], a[60:63], v[44:47], v[16:19]
  s_waitcnt lgkmcnt(14)
  v_mfma_f32_16x16x32_bf16 v[64:67], a[48:51], v[32:35], v[64:67]
  ds_read_b128 v[28:31], v14 offset:45056
  s_waitcnt lgkmcnt(3)
  v_mov_b32 v13, 26
  ds_write_b32 v126, v13 offset:16
  v_mfma_f32_16x16x32_bf16 v[68:71], a[52:55], v[32:35], v[68:71]
  s_waitcnt lgkmcnt(3)
  v_readfirstlane_b32 s84, v125
  v_mfma_f32_16x16x32_bf16 v[72:75], a[56:59], v[32:35], v[72:75]
  s_nop 2
  s_cmp_le_u32 s84, 26
  s_cbranch_scc1 L_fsl_69
L_fok_68:
  v_mfma_f32_16x16x32_bf16 v[76:79], a[60:63], v[32:35], v[76:79]
  ds_read_b64_tr_b16 a[32:33], v5 offset:16384
  v_mfma_f32_16x16x32_bf16 v[80:83], a[48:51], v[36:39], v[80:83]
  ds_read_b128 v[32:35], v14 offset:61440
  ds_read_b64_tr_b16 a[34:35], v5 offset:16896
  v_mfma_f32_16x16x32_bf16 v[84:87], a[52:55], v[36:39], v[84:87]
  ds_read_b64_tr_b16 a[36:37], v5 offset:16392
  v_mfma_f32_16x16x32_bf16 v[88:91], a[56:59], v[36:39], v[88:91]
  ds_read_b64_tr_b16 a[38:39], v5 offset:16904
  v_mfma_f32_16x16x32_bf16 v[92:95], a[60:63], v[36:39], v[92:95]
  ds_read_b64_tr_b16 a[40:41], v6 offset:16384
  v_mfma_f32_16x16x32_bf16 v[96:99], a[48:51], v[40:43], v[96:99]
  ds_read_b128 v[36:39], v14 offset:13312
  ds_read_b64_tr_b16 a[42:43], v6 offset:16896
  v_mfma_f32_16x16x32_bf16 v[100:103], a[52:55], v[40:43], v[100:103]
  ds_read_b64_tr_b16 a[44:45], v6 offset:16392
  v_mfma_f32_16x16x32_bf16 v[104:107], a[56:59], v[40:43], v[104:107]
  ds_read_b64_tr_b16 a[46:47], v6 offset:16904
  v_mfma_f32_16x16x32_bf16 v[108:111], a[60:63], v[40:43], v[108:111]
  ds_read_b32 v125, v126
  v_mfma_f32_16x16x32_bf16 v[48:51], a[64:67], v[20:23], v[48:51]
  ds_read_b128 v[40:43], v14 offset:29696
  v_mfma_f32_16x16x32_bf16 v[112:115], a[64:67], v[44:47], v[112:115]
  v_mfma_f32_16x16x32_bf16 v[52:55], a[68:71], v[20:23], v[52:55]
  v_mfma_f32_16x16x32_bf16 v[116:119], a[68:71], v[44:47], v[116:119]
  v_mfma_f32_16x16x32_bf16 v[56:59], a[72:75], v[20:23], v[56:59]
  v_mfma_f32_16x16x32_bf16 v[120:123], a[72:75], v[44:47], v[120:123]
  v_mfma_f32_16x16x32_bf16 v[60:63], a[76:79], v[20:23], v[60:63]
  v_mfma_f32_16x16x32_bf16 v[16:19], a[76:79], v[44:47], v[16:19]
  s_waitcnt lgkmcnt(14)
  v_mfma_f32_16x16x32_bf16 v[64:67], a[64:67], v[24:27], v[64:67]
  ds_read_b128 v[20:23], v14 offset:46080
  s_waitcnt lgkmcnt(3)
  v_mov_b32 v13, 27
  ds_write_b32 v126, v13 offset:16
  v_mfma_f32_16x16x32_bf16 v[68:71], a[68:71], v[24:27], v[68:71]
  s_waitcnt lgkmcnt(3)
  v_readfirstlane_b32 s84, v125
  v_mfma_f32_16x16x32_bf16 v[72:75], a[72:75], v[24:27], v[72:75]
  s_nop 2
  s_cmp_le_u32 s84, 27
  s_cbranch_scc1 L_fsl_71
L_fok_70:
  v_mfma_f32_16x16x32_bf16 v[76:79], a[76:79], v[24:27], v[76:79]
  ds_read_b64_tr_b16 a[48:49], v5 offset:32768
  v_mfma_f32_16x16x32_bf16 v[80:83], a[64:67], v[28:31], v[80:83]
  ds_read_b128 v[24:27], v14 offset:62464
  ds_read_b64_tr_b16 a[50:51], v5 offset:33280
  v_mfma_f32_16x16x32_bf16 v[84:87], a[68:71], v[28:31], v[84:87]
  ds_read_b64_tr_b16 a[52:53], v5 offset:32776
  v_mfma_f32_16x16x32_bf16 v[88:91], a[72:75], v[28:31], v[88:91]
  ds_read_b64_tr_b16 a[54:55], v5 offset:33288
  v_mfma_f32_16x16x32_bf16 v[92:95], a[76:79], v[28:31], v[92:95]
  ds_read_b64_tr_b16 a[56:57], v6 offset:32768
  v_mfma_f32_16x16x32_bf16 v[96:99], a[64:67], v[32:35], v[96:99]
  ds_read_b128 v[28:31], v14 offset:14336
  ds_read_b64_tr_b16 a[58:59], v6 offset:33280
  v_mfma_f32_16x16x32_bf16 v[100:103], a[68:71], v[32:35], v[100:103]
  ds_read_b64_tr_b16 a[60:61], v6 offset:32776
  v_mfma_f32_16x16x32_bf16 v[104:107], a[72:75], v[32:35], v[104:107]
  ds_read_b64_tr_b16 a[62:63], v6 offset:33288
  v_mfma_f32_16x16x32_bf16 v[108:111], a[76:79], v[32:35], v[108:111]
  ds_read_b32 v125, v126
  v_mfma_f32_16x16x32_bf16 v[48:51], a[80:83], v[36:39], v[48:51]
  ds_read_b128 v[32:35], v14 offset:30720
  v_mfma_f32_16x16x32_bf16 v[112:115], a[80:83], v[44:47], v[112:115]
  v_mfma_f32_16x16x32_bf16 v[52:55], a[84:87], v[36:39], v[52:55]
  v_mfma_f32_16x16x32_bf16 v[116:119], a[84:87], v[44:47], v[116:119]
  v_mfma_f32_16x16x32_bf16 v[56:59], a[88:91], v[36:39], v[56:59]
  v_mfma_f32_16x16x32_bf16 v[120:123], a[88:91], v[44:47], v[120:123]
  v_mfma_f32_16x16x32_bf16 v[60:63], a[92:95], v[36:39], v[60:63]
  v_mfma_f32_16x16x32_bf16 v[16:19], a[92:95], v[44:47], v[16:19]
  s_waitcnt lgkmcnt(14)
  v_mfma_f32_16x16x32_bf16 v[64:67], a[80:83], v[40:43], v[64:67]
  ds_read_b128 v[36:39], v14 offset:47104
  s_waitcnt lgkmcnt(3)
  v_mov_b32 v13, 28
  ds_write_b32 v126, v13 offset:16
  v_mfma_f32_16x16x32_bf16 v[68:71], a[84:87], v[40:43], v[68:71]
  s_waitcnt lgkmcnt(3)
  v_readfirstlane_b32 s84, v125
  v_mfma_f32_16x16x32_bf16 v[72:75], a[88:91], v[40:43], v[72:75]
  s_nop 2
  s_cmp_le_u32 s84, 28
  s_cbranch_scc1 L_fsl_73
L_fok_72:
  v_mfma_f32_16x16x32_bf16 v[76:79], a[92:95], v[40:43], v[76:79]
  ds_read_b64_tr_b16 a[64:65], v5 offset:49152
  v_mfma_f32_16x16x32_bf16 v[80:83], a[80:83], v[20:23], v[80:83]
  ds_read_b128 v[40:43], v14 offset:63488
  ds_read_b64_tr_b16 a[66:67], v5 offset:49664
  v_mfma_f32_16x16x32_bf16 v[84:87], a[84:87], v[20:23], v[84:87]
  ds_read_b64_tr_b16 a[68:69], v5 offset:49160
  v_mfma_f32_16x16x32_bf16 v[88:91], a[88:91], v[20:23], v[88:91]
  ds_read_b64_tr_b16 a[70:71], v5 offset:49672
  v_mfma_f32_16x16x32_bf16 v[92:95], a[92:95], v[20:23], v[92:95]
  ds_read_b64_tr_b16 a[72:73], v6 offset:49152
  v_mfma_f32_16x16x32_bf16 v[96:99], a[80:83], v[24:27], v[96:99]
  ds_read_b128 v[20:23], v14 offset:15360
  ds_read_b64_tr_b16 a[74:75], v6 offset:49664
  v_mfma_f32_16x16x32_bf16 v[100:103], a[84:87], v[24:27], v[100:103]
  ds_read_b64_tr_b16 a[76:77], v6 offset:49160
  v_mfma_f32_16x16x32_bf16 v[104:107], a[88:91], v[24:27], v[104:107]
  ds_read_b64_tr_b16 a[78:79], v6 offset:49672
  v_mfma_f32_16x16x32_bf16 v[108:111], a[92:95], v[24:27], v[108:111]
  ds_read_b32 v125, v126
  v_mfma_f32_16x16x32_bf16 v[48:51], a[96:99], v[28:31], v[48:51]
  ds_read_b128 v[24:27], v14 offset:31744
  v_mfma_f32_16x16x32_bf16 v[112:115], a[96:99], v[44:47], v[112:115]
  v_mfma_f32_16x16x32_bf16 v[52:55], a[100:103], v[28:31], v[52:55]
  v_mfma_f32_16x16x32_bf16 v[116:119], a[100:103], v[44:47], v[116:119]
  v_mfma_f32_16x16x32_bf16 v[56:59], a[104:107], v[28:31], v[56:59]
  v_mfma_f32_16x16x32_bf16 v[120:123], a[104:107], v[44:47], v[120:123]
  v_mfma_f32_16x16x32_bf16 v[60:63], a[108:111], v[28:31], v[60:63]
  v_mfma_f32_16x16x32_bf16 v[16:19], a[108:111], v[44:47], v[16:19]
  s_waitcnt lgkmcnt(14)
  v_mfma_f32_16x16x32_bf16 v[64:67], a[96:99], v[32:35], v[64:67]
  ds_read_b128 v[28:31], v14 offset:48128
  s_waitcnt lgkmcnt(3)
  v_mov_b32 v13, 29
  ds_write_b32 v126, v13 offset:16
  v_mfma_f32_16x16x32_bf16 v[68:71], a[100:103], v[32:35], v[68:71]
  s_waitcnt lgkmcnt(3)
  v_readfirstlane_b32 s84, v125
  v_mfma_f32_16x16x32_bf16 v[72:75], a[104:107], v[32:35], v[72:75]
  s_nop 2
  s_cmp_le_u32 s84, 29
  s_cbranch_scc1 L_fsl_75
L_fok_74:
  v_mfma_f32_16x16x32_bf16 v[76:79], a[108:111], v[32:35], v[76:79]
  ds_read_b64_tr_b16 a[80:81], v15 offset:49152
  v_mfma_f32_16x16x32_bf16 v[80:83], a[96:99], v[36:39], v[80:83]
  ds_read_b128 v[32:35], v14 offset:64512
  ds_read_b64_tr_b16 a[82:83], v15 offset:49664
  v_mfma_f32_16x16x32_bf16 v[84:87], a[100:103], v[36:39], v[84:87]
  ds_read_b64_tr_b16 a[84:85], v15 offset:49160
  v_mfma_f32_16x16x32_bf16 v[88:91], a[104:107], v[36:39], v[88:91]
  ds_read_b64_tr_b16 a[86:87], v15 offset:49672
  v_mfma_f32_16x16x32_bf16 v[92:95], a[108:111], v[36:39], v[92:95]
  ds_read_b64_tr_b16 a[88:89], v124 offset:49152
  v_mfma_f32_16x16x32_bf16 v[96:99], a[96:99], v[40:43], v[96:99]
  ds_read_b64_tr_b16 a[90:91], v124 offset:49664
  v_mfma_f32_16x16x32_bf16 v[100:103], a[100:103], v[40:43], v[100:103]
  ds_read_b64_tr_b16 a[92:93], v124 offset:49160
  v_mfma_f32_16x16x32_bf16 v[104:107], a[104:107], v[40:43], v[104:107]
  ds_read_b64_tr_b16 a[94:95], v124 offset:49672
  v_mfma_f32_16x16x32_bf16 v[108:111], a[108:111], v[40:43], v[108:111]
  ds_read_b32 v125, v126
  v_mfma_f32_16x16x32_bf16 v[48:51], a[112:115], v[20:23], v[48:51]
  v_mfma_f32_16x16x32_bf16 v[112:115], a[112:115], v[44:47], v[112:115]
  v_mfma_f32_16x16x32_bf16 v[52:55], a[116:119], v[20:23], v[52:55]
  v_mfma_f32_16x16x32_bf16 v[116:119], a[116:119], v[44:47], v[116:119]
  v_mfma_f32_16x16x32_bf16 v[56:59], a[120:123], v[20:23], v[56:59]
  v_mfma_f32_16x16x32_bf16 v[120:123], a[120:123], v[44:47], v[120:123]
  v_mfma_f32_16x16x32_bf16 v[60:63], a[124:127], v[20:23], v[60:63]
  v_mfma_f32_16x16x32_bf16 v[16:19], a[124:127], v[44:47], v[16:19]
  s_waitcnt lgkmcnt(12)
  v_mfma_f32_16x16x32_bf16 v[64:67], a[112:115], v[24:27], v[64:67]
  s_waitcnt lgkmcnt(1)
  v_mov_b32 v13, 30
  ds_write_b32 v126, v13 offset:16
  v_mfma_f32_16x16x32_bf16 v[68:71], a[116:119], v[24:27], v[68:71]
  s_waitcnt lgkmcnt(1)
  v_readfirstlane_b32 s84, v125
  v_mfma_f32_16x16x32_bf16 v[72:75], a[120:123], v[24:27], v[72:75]
  s_nop 2
  s_cmp_le_u32 s84, 30
  s_cbranch_scc1 L_fsl_77
L_fok_76:
  v_mfma_f32_16x16x32_bf16 v[76:79], a[124:127], v[24:27], v[76:79]
  ds_read_b64_tr_b16 a[96:97], v5 offset:0
  v_mfma_f32_16x16x32_bf16 v[80:83], a[112:115], v[28:31], v[80:83]
  ds_read_b64_tr_b16 a[98:99], v5 offset:512
  v_mfma_f32_16x16x32_bf16 v[84:87], a[116:119], v[28:31], v[84:87]
  ds_read_b64_tr_b16 a[100:101], v5 offset:8
  v_mfma_f32_16x16x32_bf16 v[88:91], a[120:123], v[28:31], v[88:91]
  ds_read_b64_tr_b16 a[102:103], v5 offset:520
  v_mfma_f32_16x16x32_bf16 v[92:95], a[124:127], v[28:31], v[92:95]
  ds_read_b64_tr_b16 a[104:105], v6 offset:0
  v_mfma_f32_16x16x32_bf16 v[96:99], a[112:115], v[32:35], v[96:99]
  ds_read_b64_tr_b16 a[106:107], v6 offset:512
  v_mfma_f32_16x16x32_bf16 v[100:103], a[116:119], v[32:35], v[100:103]
  ds_read_b64_tr_b16 a[108:109], v6 offset:8
  v_mfma_f32_16x16x32_bf16 v[104:107], a[120:123], v[32:35], v[104:107]
  ds_read_b64_tr_b16 a[110:111], v6 offset:520
  v_mfma_f32_16x16x32_bf16 v[108:111], a[124:127], v[32:35], v[108:111]
  ds_read_b32 v125, v126
  s_waitcnt lgkmcnt(1)
  v_mov_b32 v13, 31
  ds_write_b32 v126, v13 offset:16
  v_lshlrev_b32 v9, 3, v2
  v_add_u32 v9, 148480, v9
  ds_read_b64 v[20:21], v9 offset:0
  ds_read_b64 v[22:23], v9 offset:128
  ds_read_b64 v[24:25], v9 offset:256
  ds_read_b64 v[26:27], v9 offset:384
  s_mov_b32 s50, 0x3fb8aa3b
  s_mov_b32 s51, s50
  s_lshl_b32 s48, s41, 3
  s_lshl_b32 s49, s42, 1
  s_add_u32 s48, s48, s49
  s_lshl_b32 s48, s48, 10
  s_add_u32 s48, s48, s3
  s_add_u32 s48, s48, 8388608
  s_waitcnt lgkmcnt(0)
  v_pk_mul_f32 v[28:29], v[112:113], v[20:21] op_sel:[0,1] op_sel_hi:[1,1]
  v_pk_mul_f32 v[32:33], v[114:115], v[20:21] op_sel:[0,1] op_sel_hi:[1,1]
  v_pk_mul_f32 v[36:37], v[116:117], v[20:21] op_sel:[0,1] op_sel_hi:[1,1]
  v_pk_mul_f32 v[40:41], v[118:119], v[20:21] op_sel:[0,1] op_sel_hi:[1,1]
  v_pk_fma_f32 v[48:49], v[48:49], v[20:21], v[28:29] op_sel_hi:[1,0,1]
  v_pk_fma_f32 v[50:51], v[50:51], v[20:21], v[32:33] op_sel_hi:[1,0,1]
  v_pk_fma_f32 v[52:53], v[52:53], v[20:21], v[36:37] op_sel_hi:[1,0,1]
  v_pk_fma_f32 v[54:55], v[54:55], v[20:21], v[40:41] op_sel_hi:[1,0,1]
  v_exp_f32_e64 v28, -v48
  v_exp_f32_e64 v32, -v50
  v_exp_f32_e64 v36, -v52
  v_exp_f32_e64 v40, -v54
  v_exp_f32_e64 v29, -v49
  v_exp_f32_e64 v33, -v51
  v_exp_f32_e64 v37, -v53
  v_exp_f32_e64 v41, -v55
  v_pk_fma_f32 v[28:29], v[28:29], s[50:51], s[50:51]
  v_pk_fma_f32 v[32:33], v[32:33], s[50:51], s[50:51]
  v_pk_fma_f32 v[36:37], v[36:37], s[50:51], s[50:51]
  v_pk_fma_f32 v[40:41], v[40:41], s[50:51], s[50:51]
  v_rcp_f32 v28, v28
  v_rcp_f32 v32, v32
  v_rcp_f32 v36, v36
  v_rcp_f32 v40, v40
  v_rcp_f32 v29, v29
  v_rcp_f32 v33, v33
  v_rcp_f32 v37, v37
  v_rcp_f32 v41, v41
  v_pk_mul_f32 v[48:49], v[48:49], v[28:29]
  v_pk_mul_f32 v[50:51], v[50:51], v[32:33]
  v_pk_mul_f32 v[52:53], v[52:53], v[36:37]
  v_pk_mul_f32 v[54:55], v[54:55], v[40:41]
  v_cvt_pk_bf16_f32 v48, v48, v49
  v_cvt_pk_bf16_f32 v49, v50, v51
  v_cvt_pk_bf16_f32 v50, v52, v53
  v_cvt_pk_bf16_f32 v51, v54, v55
  v_pk_mul_f32 v[28:29], v[120:121], v[20:21] op_sel:[0,1] op_sel_hi:[1,1]
  v_pk_mul_f32 v[32:33], v[122:123], v[20:21] op_sel:[0,1] op_sel_hi:[1,1]
  v_pk_mul_f32 v[36:37], v[16:17], v[20:21] op_sel:[0,1] op_sel_hi:[1,1]
  v_pk_mul_f32 v[40:41], v[18:19], v[20:21] op_sel:[0,1] op_sel_hi:[1,1]
  v_pk_fma_f32 v[56:57], v[56:57], v[20:21], v[28:29] op_sel_hi:[1,0,1]
  v_pk_fma_f32 v[58:59], v[58:59], v[20:21], v[32:33] op_sel_hi:[1,0,1]
  v_pk_fma_f32 v[60:61], v[60:61], v[20:21], v[36:37] op_sel_hi:[1,0,1]
  v_pk_fma_f32 v[62:63], v[62:63], v[20:21], v[40:41] op_sel_hi:[1,0,1]
  v_exp_f32_e64 v28, -v56
  v_exp_f32_e64 v32, -v58
  v_exp_f32_e64 v36, -v60
  v_exp_f32_e64 v40, -v62
  v_exp_f32_e64 v29, -v57
  v_exp_f32_e64 v33, -v59
  v_exp_f32_e64 v37, -v61
  v_exp_f32_e64 v41, -v63
  v_pk_fma_f32 v[28:29], v[28:29], s[50:51], s[50:51]
  v_pk_fma_f32 v[32:33], v[32:33], s[50:51], s[50:51]
  v_pk_fma_f32 v[36:37], v[36:37], s[50:51], s[50:51]
  v_pk_fma_f32 v[40:41], v[40:41], s[50:51], s[50:51]
  v_rcp_f32 v28, v28
  v_rcp_f32 v32, v32
  v_rcp_f32 v36, v36
  v_rcp_f32 v40, v40
  v_rcp_f32 v29, v29
  v_rcp_f32 v33, v33
  v_rcp_f32 v37, v37
  v_rcp_f32 v41, v41
  v_pk_mul_f32 v[56:57], v[56:57], v[28:29]
  v_pk_mul_f32 v[58:59], v[58:59], v[32:33]
  v_pk_mul_f32 v[60:61], v[60:61], v[36:37]
  v_pk_mul_f32 v[62:63], v[62:63], v[40:41]
  v_cvt_pk_bf16_f32 v56, v56, v57
  v_cvt_pk_bf16_f32 v57, v58, v59
  v_cvt_pk_bf16_f32 v58, v60, v61
  v_cvt_pk_bf16_f32 v59, v62, v63
  v_pk_mul_f32 v[28:29], v[112:113], v[22:23] op_sel:[0,1] op_sel_hi:[1,1]
  v_pk_mul_f32 v[32:33], v[114:115], v[22:23] op_sel:[0,1] op_sel_hi:[1,1]
  v_pk_mul_f32 v[36:37], v[116:117], v[22:23] op_sel:[0,1] op_sel_hi:[1,1]
  v_pk_mul_f32 v[40:41], v[118:119], v[22:23] op_sel:[0,1] op_sel_hi:[1,1]
  v_pk_fma_f32 v[64:65], v[64:65], v[22:23], v[28:29] op_sel_hi:[1,0,1]
  v_pk_fma_f32 v[66:67], v[66:67], v[22:23], v[32:33] op_sel_hi:[1,0,1]
  v_pk_fma_f32 v[68:69], v[68:69], v[22:23], v[36:37] op_sel_hi:[1,0,1]
  v_pk_fma_f32 v[70:71], v[70:71], v[22:23], v[40:41] op_sel_hi:[1,0,1]
  v_exp_f32_e64 v28, -v64
  v_exp_f32_e64 v32, -v66
  v_exp_f32_e64 v36, -v68
  v_exp_f32_e64 v40, -v70
  v_exp_f32_e64 v29, -v65
  v_exp_f32_e64 v33, -v67
  v_exp_f32_e64 v37, -v69
  v_exp_f32_e64 v41, -v71
  v_pk_fma_f32 v[28:29], v[28:29], s[50:51], s[50:51]
  v_pk_fma_f32 v[32:33], v[32:33], s[50:51], s[50:51]
  v_pk_fma_f32 v[36:37], v[36:37], s[50:51], s[50:51]
  v_pk_fma_f32 v[40:41], v[40:41], s[50:51], s[50:51]
  v_rcp_f32 v28, v28
  v_rcp_f32 v32, v32
  v_rcp_f32 v36, v36
  v_rcp_f32 v40, v40
  v_rcp_f32 v29, v29
  v_rcp_f32 v33, v33
  v_rcp_f32 v37, v37
  v_rcp_f32 v41, v41
  v_pk_mul_f32 v[64:65], v[64:65], v[28:29]
  v_pk_mul_f32 v[66:67], v[66:67], v[32:33]
  v_pk_mul_f32 v[68:69], v[68:69], v[36:37]
  v_pk_mul_f32 v[70:71], v[70:71], v[40:41]
  v_cvt_pk_bf16_f32 v64, v64, v65
  v_cvt_pk_bf16_f32 v65, v66, v67
  v_cvt_pk_bf16_f32 v66, v68, v69
  v_cvt_pk_bf16_f32 v67, v70, v71
  v_pk_mul_f32 v[28:29], v[120:121], v[22:23] op_sel:[0,1] op_sel_hi:[1,1]
  v_pk_mul_f32 v[32:33], v[122:123], v[22:23] op_sel:[0,1] op_sel_hi:[1,1]
  v_pk_mul_f32 v[36:37], v[16:17], v[22:23] op_sel:[0,1] op_sel_hi:[1,1]
  v_pk_mul_f32 v[40:41], v[18:19], v[22:23] op_sel:[0,1] op_sel_hi:[1,1]
  v_pk_fma_f32 v[72:73], v[72:73], v[22:23], v[28:29] op_sel_hi:[1,0,1]
  v_pk_fma_f32 v[74:75], v[74:75], v[22:23], v[32:33] op_sel_hi:[1,0,1]
  v_pk_fma_f32 v[76:77], v[76:77], v[22:23], v[36:37] op_sel_hi:[1,0,1]
  v_pk_fma_f32 v[78:79], v[78:79], v[22:23], v[40:41] op_sel_hi:[1,0,1]
  v_exp_f32_e64 v28, -v72
  v_exp_f32_e64 v32, -v74
  v_exp_f32_e64 v36, -v76
  v_exp_f32_e64 v40, -v78
  v_exp_f32_e64 v29, -v73
  v_exp_f32_e64 v33, -v75
  v_exp_f32_e64 v37, -v77
  v_exp_f32_e64 v41, -v79
  v_pk_fma_f32 v[28:29], v[28:29], s[50:51], s[50:51]
  v_pk_fma_f32 v[32:33], v[32:33], s[50:51], s[50:51]
  v_pk_fma_f32 v[36:37], v[36:37], s[50:51], s[50:51]
  v_pk_fma_f32 v[40:41], v[40:41], s[50:51], s[50:51]
  v_rcp_f32 v28, v28
  v_rcp_f32 v32, v32
  v_rcp_f32 v36, v36
  v_rcp_f32 v40, v40
  v_rcp_f32 v29, v29
  v_rcp_f32 v33, v33
  v_rcp_f32 v37, v37
  v_rcp_f32 v41, v41
  v_pk_mul_f32 v[72:73], v[72:73], v[28:29]
  v_pk_mul_f32 v[74:75], v[74:75], v[32:33]
  v_pk_mul_f32 v[76:77], v[76:77], v[36:37]
  v_pk_mul_f32 v[78:79], v[78:79], v[40:41]
  v_cvt_pk_bf16_f32 v72, v72, v73
  v_cvt_pk_bf16_f32 v73, v74, v75
  v_cvt_pk_bf16_f32 v74, v76, v77
  v_cvt_pk_bf16_f32 v75, v78, v79
  v_pk_mul_f32 v[28:29], v[112:113], v[24:25] op_sel:[0,1] op_sel_hi:[1,1]
  v_pk_mul_f32 v[32:33], v[114:115], v[24:25] op_sel:[0,1] op_sel_hi:[1,1]
  v_pk_mul_f32 v[36:37], v[116:117], v[24:25] op_sel:[0,1] op_sel_hi:[1,1]
  v_pk_mul_f32 v[40:41], v[118:119], v[24:25] op_sel:[0,1] op_sel_hi:[1,1]
  v_pk_fma_f32 v[80:81], v[80:81], v[24:25], v[28:29] op_sel_hi:[1,0,1]
  v_pk_fma_f32 v[82:83], v[82:83], v[24:25], v[32:33] op_sel_hi:[1,0,1]
  v_pk_fma_f32 v[84:85], v[84:85], v[24:25], v[36:37] op_sel_hi:[1,0,1]
  v_pk_fma_f32 v[86:87], v[86:87], v[24:25], v[40:41] op_sel_hi:[1,0,1]
  v_exp_f32_e64 v28, -v80
  v_exp_f32_e64 v32, -v82
  v_exp_f32_e64 v36, -v84
  v_exp_f32_e64 v40, -v86
  v_exp_f32_e64 v29, -v81
  v_exp_f32_e64 v33, -v83
  v_exp_f32_e64 v37, -v85
  v_exp_f32_e64 v41, -v87
  v_pk_fma_f32 v[28:29], v[28:29], s[50:51], s[50:51]
  v_pk_fma_f32 v[32:33], v[32:33], s[50:51], s[50:51]
  v_pk_fma_f32 v[36:37], v[36:37], s[50:51], s[50:51]
  v_pk_fma_f32 v[40:41], v[40:41], s[50:51], s[50:51]
  v_rcp_f32 v28, v28
  v_rcp_f32 v32, v32
  v_rcp_f32 v36, v36
  v_rcp_f32 v40, v40
  v_rcp_f32 v29, v29
  v_rcp_f32 v33, v33
  v_rcp_f32 v37, v37
  v_rcp_f32 v41, v41
  v_pk_mul_f32 v[80:81], v[80:81], v[28:29]
  v_pk_mul_f32 v[82:83], v[82:83], v[32:33]
  v_pk_mul_f32 v[84:85], v[84:85], v[36:37]
  v_pk_mul_f32 v[86:87], v[86:87], v[40:41]
  v_cvt_pk_bf16_f32 v80, v80, v81
  v_cvt_pk_bf16_f32 v81, v82, v83
  v_cvt_pk_bf16_f32 v82, v84, v85
  v_cvt_pk_bf16_f32 v83, v86, v87
  v_pk_mul_f32 v[28:29], v[120:121], v[24:25] op_sel:[0,1] op_sel_hi:[1,1]
  v_pk_mul_f32 v[32:33], v[122:123], v[24:25] op_sel:[0,1] op_sel_hi:[1,1]
  v_pk_mul_f32 v[36:37], v[16:17], v[24:25] op_sel:[0,1] op_sel_hi:[1,1]
  v_pk_mul_f32 v[40:41], v[18:19], v[24:25] op_sel:[0,1] op_sel_hi:[1,1]
  v_pk_fma_f32 v[88:89], v[88:89], v[24:25], v[28:29] op_sel_hi:[1,0,1]
  v_pk_fma_f32 v[90:91], v[90:91], v[24:25], v[32:33] op_sel_hi:[1,0,1]
  v_pk_fma_f32 v[92:93], v[92:93], v[24:25], v[36:37] op_sel_hi:[1,0,1]
  v_pk_fma_f32 v[94:95], v[94:95], v[24:25], v[40:41] op_sel_hi:[1,0,1]
  v_exp_f32_e64 v28, -v88
  v_exp_f32_e64 v32, -v90
  v_exp_f32_e64 v36, -v92
  v_exp_f32_e64 v40, -v94
  v_exp_f32_e64 v29, -v89
  v_exp_f32_e64 v33, -v91
  v_exp_f32_e64 v37, -v93
  v_exp_f32_e64 v41, -v95
  v_pk_fma_f32 v[28:29], v[28:29], s[50:51], s[50:51]
  v_pk_fma_f32 v[32:33], v[32:33], s[50:51], s[50:51]
  v_pk_fma_f32 v[36:37], v[36:37], s[50:51], s[50:51]
  v_pk_fma_f32 v[40:41], v[40:41], s[50:51], s[50:51]
  v_rcp_f32 v28, v28
  v_rcp_f32 v32, v32
  v_rcp_f32 v36, v36
  v_rcp_f32 v40, v40
  v_rcp_f32 v29, v29
  v_rcp_f32 v33, v33
  v_rcp_f32 v37, v37
  v_rcp_f32 v41, v41
  v_pk_mul_f32 v[88:89], v[88:89], v[28:29]
  v_pk_mul_f32 v[90:91], v[90:91], v[32:33]
  v_pk_mul_f32 v[92:93], v[92:93], v[36:37]
  v_pk_mul_f32 v[94:95], v[94:95], v[40:41]
  v_cvt_pk_bf16_f32 v88, v88, v89
  v_cvt_pk_bf16_f32 v89, v90, v91
  v_cvt_pk_bf16_f32 v90, v92, v93
  v_cvt_pk_bf16_f32 v91, v94, v95
  v_pk_mul_f32 v[28:29], v[112:113], v[26:27] op_sel:[0,1] op_sel_hi:[1,1]
  v_pk_mul_f32 v[32:33], v[114:115], v[26:27] op_sel:[0,1] op_sel_hi:[1,1]
  v_pk_mul_f32 v[36:37], v[116:117], v[26:27] op_sel:[0,1] op_sel_hi:[1,1]
  v_pk_mul_f32 v[40:41], v[118:119], v[26:27] op_sel:[0,1] op_sel_hi:[1,1]
  v_pk_fma_f32 v[96:97], v[96:97], v[26:27], v[28:29] op_sel_hi:[1,0,1]
  v_pk_fma_f32 v[98:99], v[98:99], v[26:27], v[32:33] op_sel_hi:[1,0,1]
  v_pk_fma_f32 v[100:101], v[100:101], v[26:27], v[36:37] op_sel_hi:[1,0,1]
  v_pk_fma_f32 v[102:103], v[102:103], v[26:27], v[40:41] op_sel_hi:[1,0,1]
  v_exp_f32_e64 v28, -v96
  v_exp_f32_e64 v32, -v98
  v_exp_f32_e64 v36, -v100
  v_exp_f32_e64 v40, -v102
  v_exp_f32_e64 v29, -v97
  v_exp_f32_e64 v33, -v99
  v_exp_f32_e64 v37, -v101
  v_exp_f32_e64 v41, -v103
  v_pk_fma_f32 v[28:29], v[28:29], s[50:51], s[50:51]
  v_pk_fma_f32 v[32:33], v[32:33], s[50:51], s[50:51]
  v_pk_fma_f32 v[36:37], v[36:37], s[50:51], s[50:51]
  v_pk_fma_f32 v[40:41], v[40:41], s[50:51], s[50:51]
  v_rcp_f32 v28, v28
  v_rcp_f32 v32, v32
  v_rcp_f32 v36, v36
  v_rcp_f32 v40, v40
  v_rcp_f32 v29, v29
  v_rcp_f32 v33, v33
  v_rcp_f32 v37, v37
  v_rcp_f32 v41, v41
  v_pk_mul_f32 v[96:97], v[96:97], v[28:29]
  v_pk_mul_f32 v[98:99], v[98:99], v[32:33]
  v_pk_mul_f32 v[100:101], v[100:101], v[36:37]
  v_pk_mul_f32 v[102:103], v[102:103], v[40:41]
  v_cvt_pk_bf16_f32 v96, v96, v97
  v_cvt_pk_bf16_f32 v97, v98, v99
  v_cvt_pk_bf16_f32 v98, v100, v101
  v_cvt_pk_bf16_f32 v99, v102, v103
  v_pk_mul_f32 v[28:29], v[120:121], v[26:27] op_sel:[0,1] op_sel_hi:[1,1]
  v_pk_mul_f32 v[32:33], v[122:123], v[26:27] op_sel:[0,1] op_sel_hi:[1,1]
  v_pk_mul_f32 v[36:37], v[16:17], v[26:27] op_sel:[0,1] op_sel_hi:[1,1]
  v_pk_mul_f32 v[40:41], v[18:19], v[26:27] op_sel:[0,1] op_sel_hi:[1,1]
  v_pk_fma_f32 v[104:105], v[104:105], v[26:27], v[28:29] op_sel_hi:[1,0,1]
  v_pk_fma_f32 v[106:107], v[106:107], v[26:27], v[32:33] op_sel_hi:[1,0,1]
  v_pk_fma_f32 v[108:109], v[108:109], v[26:27], v[36:37] op_sel_hi:[1,0,1]
  v_pk_fma_f32 v[110:111], v[110:111], v[26:27], v[40:41] op_sel_hi:[1,0,1]
  v_exp_f32_e64 v28, -v104
  v_exp_f32_e64 v32, -v106
  v_exp_f32_e64 v36, -v108
  v_exp_f32_e64 v40, -v110
  v_exp_f32_e64 v29, -v105
  v_exp_f32_e64 v33, -v107
  v_exp_f32_e64 v37, -v109
  v_exp_f32_e64 v41, -v111
  v_pk_fma_f32 v[28:29], v[28:29], s[50:51], s[50:51]
  v_pk_fma_f32 v[32:33], v[32:33], s[50:51], s[50:51]
  v_pk_fma_f32 v[36:37], v[36:37], s[50:51], s[50:51]
  v_pk_fma_f32 v[40:41], v[40:41], s[50:51], s[50:51]
  v_rcp_f32 v28, v28
  v_rcp_f32 v32, v32
  v_rcp_f32 v36, v36
  v_rcp_f32 v40, v40
  v_rcp_f32 v29, v29
  v_rcp_f32 v33, v33
  v_rcp_f32 v37, v37
  v_rcp_f32 v41, v41
  v_pk_mul_f32 v[104:105], v[104:105], v[28:29]
  v_pk_mul_f32 v[106:107], v[106:107], v[32:33]
  v_pk_mul_f32 v[108:109], v[108:109], v[36:37]
  v_pk_mul_f32 v[110:111], v[110:111], v[40:41]
  v_cvt_pk_bf16_f32 v104, v104, v105
  v_cvt_pk_bf16_f32 v105, v106, v107
  v_cvt_pk_bf16_f32 v106, v108, v109
  v_cvt_pk_bf16_f32 v107, v110, v111
  s_cmp_eq_u32 s41, 7
  s_cbranch_scc1 L_k3skip
  s_cmp_eq_u32 s43, 1
  s_cbranch_scc1 L_fast_78
  s_add_u32 s49, s48, 0
  buffer_store_dwordx4 v[48:51], v4, s[36:39], s49 offen sc1
  s_add_u32 s49, s48, 1024
  buffer_store_dwordx4 v[56:59], v4, s[36:39], s49 offen sc1
  s_add_u32 s49, s48, 57344
  buffer_store_dwordx4 v[64:67], v4, s[36:39], s49 offen sc1
  s_add_u32 s49, s48, 58368
  buffer_store_dwordx4 v[72:75], v4, s[36:39], s49 offen sc1
  s_add_u32 s49, s48, 114688
  buffer_store_dwordx4 v[80:83], v4, s[36:39], s49 offen sc1
  s_add_u32 s49, s48, 115712
  buffer_store_dwordx4 v[88:91], v4, s[36:39], s49 offen sc1
  s_add_u32 s49, s48, 172032
  buffer_store_dwordx4 v[96:99], v4, s[36:39], s49 offen sc1
  s_add_u32 s49, s48, 173056
  buffer_store_dwordx4 v[104:107], v4, s[36:39], s49 offen sc1
  s_branch L_stend_79
L_fast_78:
  s_add_u32 s49, s48, 0
  buffer_store_dwordx4 v[48:51], v4, s[36:39], s49 offen
  s_add_u32 s49, s48, 1024
  buffer_store_dwordx4 v[56:59], v4, s[36:39], s49 offen
  s_add_u32 s49, s48, 57344
  buffer_store_dwordx4 v[64:67], v4, s[36:39], s49 offen
  s_add_u32 s49, s48, 58368
  buffer_store_dwordx4 v[72:75], v4, s[36:39], s49 offen
  s_add_u32 s49, s48, 114688
  buffer_store_dwordx4 v[80:83], v4, s[36:39], s49 offen
  s_add_u32 s49, s48, 115712
  buffer_store_dwordx4 v[88:91], v4, s[36:39], s49 offen
  s_add_u32 s49, s48, 172032
  buffer_store_dwordx4 v[96:99], v4, s[36:39], s49 offen
  s_add_u32 s49, s48, 173056
  buffer_store_dwordx4 v[104:107], v4, s[36:39], s49 offen
L_stend_79:
  v_mov_b32 v9, 1
  v_mov_b32 v10, 256
  s_waitcnt vmcnt(0)
  s_mov_b64 exec, 1
  s_cmp_eq_u32 s43, 1
  s_cbranch_scc1 L_fast_80
  buffer_store_dword v9, v10, s[36:39], s76 offen sc1
  s_branch L_stend_81
L_fast_80:
  buffer_store_dword v9, v10, s[36:39], s76 offen
L_stend_81:
  s_mov_b64 exec, -1
L_k3skip:
  s_cmp_le_u32 s84, 31
  s_cbranch_scc1 L_fsl_83
L_fok_82:
  ds_read_b64_tr_b16 a[112:113], v5 offset:16384
  ds_read_b64_tr_b16 a[114:115], v5 offset:16896
  ds_read_b64_tr_b16 a[116:117], v5 offset:16392
  ds_read_b64_tr_b16 a[118:119], v5 offset:16904
  ds_read_b64_tr_b16 a[120:121], v6 offset:16384
  ds_read_b64_tr_b16 a[122:123], v6 offset:16896
  ds_read_b64_tr_b16 a[124:125], v6 offset:16392
  ds_read_b64_tr_b16 a[126:127], v6 offset:16904
  s_waitcnt lgkmcnt(0)
  v_mov_b32 v13, 32
  ds_write_b32 v126, v13 offset:16
  s_mul_i32 s49, s42, 28
  v_lshlrev_b32 v10, 2, v1
  v_add_u32 v10, s49, v10
  s_mul_i32 s49, s42, 14336
  s_add_u32 s50, s3, s49
  s_add_u32 s91, s50, 8388608
  s_add_u32 s92, s91, 57344
  s_add_u32 s93, s91, 114688
  s_add_u32 s94, s91, 172032
  s_waitcnt lgkmcnt(0)
  s_lshl_b32 s48, s40, 9
  s_add_u32 s48, s48, 256
  s_mov_b64 exec, 0x7f
L_poll_84:
  buffer_load_dword v9, v10, s[36:39], s48 offen sc1
  s_waitcnt vmcnt(0)
  v_cmp_eq_u32 vcc, 0, v9
  s_nop 3
  s_cmp_lg_u64 vcc, 0
  s_cbranch_scc1 L_poll_84
L_poll_84x:
  s_mov_b64 exec, -1
  s_lshr_b32 s44, s40, 3
  s_mul_i32 s44, s44, 7
  s_lshr_b32 s44, s44, 1
  s_and_b32 s48, s40, 3
  s_add_u32 s44, s44, s48
  s_lshl_b32 s44, s44, 10
  s_add_u32 s51, s91, s44
  buffer_load_dwordx4 v[16:19], v4, s[36:39], s51 offen sc1
  s_add_u32 s51, s92, s44
  buffer_load_dwordx4 v[20:23], v4, s[36:39], s51 offen sc1
  s_add_u32 s51, s93, s44
  buffer_load_dwordx4 v[24:27], v4, s[36:39], s51 offen sc1
  s_add_u32 s51, s94, s44
  buffer_load_dwordx4 v[28:31], v4, s[36:39], s51 offen sc1
  s_add_u32 s44, s44, 1024
  s_cmp_eq_u32 s44, 14336
  s_cselect_b32 s44, 0, s44
  s_add_u32 s51, s91, s44
  buffer_load_dwordx4 v[32:35], v4, s[36:39], s51 offen sc1
  s_add_u32 s51, s92, s44
  buffer_load_dwordx4 v[36:39], v4, s[36:39], s51 offen sc1
  s_add_u32 s51, s93, s44
  buffer_load_dwordx4 v[40:43], v4, s[36:39], s51 offen sc1
  s_add_u32 s51, s94, s44
  buffer_load_dwordx4 v[44:47], v4, s[36:39], s51 offen sc1
  s_add_u32 s44, s44, 1024
  s_cmp_eq_u32 s44, 14336
  s_cselect_b32 s44, 0, s44
  s_add_u32 s51, s91, s44
  buffer_load_dwordx4 v[112:115], v4, s[36:39], s51 offen sc1
  s_add_u32 s51, s92, s44
  buffer_load_dwordx4 v[116:119], v4, s[36:39], s51 offen sc1
  s_waitcnt vmcnt(9)
  v_mfma_f32_16x16x32_bf16 v[48:51], a[0:3], v[16:19], 0
  s_add_u32 s51, s93, s44
  buffer_load_dwordx4 v[120:123], v4, s[36:39], s51 offen sc1
  ds_read_b32 v125, v126
  v_mfma_f32_16x16x32_bf16 v[52:55], a[4:7], v[16:19], 0
  v_mfma_f32_16x16x32_bf16 v[56:59], a[8:11], v[16:19], 0
  v_mfma_f32_16x16x32_bf16 v[60:63], a[12:15], v[16:19], 0
  s_waitcnt vmcnt(9)
  v_mfma_f32_16x16x32_bf16 v[64:67], a[0:3], v[20:23], 0
  s_add_u32 s51, s94, s44
  buffer_load_dwordx4 v[16:19], v4, s[36:39], s51 offen sc1
  s_add_u32 s44, s44, 1024
  s_cmp_eq_u32 s44, 14336
  s_cselect_b32 s44, 0, s44
  v_mfma_f32_16x16x32_bf16 v[68:71], a[4:7], v[20:23], 0
  v_mfma_f32_16x16x32_bf16 v[72:75], a[8:11], v[20:23], 0
  v_mfma_f32_16x16x32_bf16 v[76:79], a[12:15], v[20:23], 0
  s_waitcnt vmcnt(9)
  v_mfma_f32_16x16x32_bf16 v[80:83], a[0:3], v[24:27], 0
  s_add_u32 s51, s91, s44
  buffer_load_dwordx4 v[20:23], v4, s[36:39], s51 offen sc1
  v_mfma_f32_16x16x32_bf16 v[84:87], a[4:7], v[24:27], 0
  v_mfma_f32_16x16x32_bf16 v[88:91], a[8:11], v[24:27], 0
  v_mfma_f32_16x16x32_bf16 v[92:95], a[12:15], v[24:27], 0
  s_waitcnt vmcnt(9)
  v_mfma_f32_16x16x32_bf16 v[96:99], a[0:3], v[28:31], 0
  s_add_u32 s51, s92, s44
  buffer_load_dwordx4 v[24:27], v4, s[36:39], s51 offen sc1
  v_mfma_f32_16x16x32_bf16 v[100:103], a[4:7], v[28:31], 0
  v_mfma_f32_16x16x32_bf16 v[104:107], a[8:11], v[28:31], 0
  v_mfma_f32_16x16x32_bf16 v[108:111], a[12:15], v[28:31], 0
  s_waitcnt vmcnt(9)
  v_mfma_f32_16x16x32_bf16 v[48:51], a[16:19], v[32:35], v[48:51]
  s_add_u32 s51, s93, s44
  buffer_load_dwordx4 v[28:31], v4, s[36:39], s51 offen sc1
  s_waitcnt lgkmcnt(0)
  v_readfirstlane_b32 s84, v125
  v_mfma_f32_16x16x32_bf16 v[52:55], a[20:23], v[32:35], v[52:55]
  s_nop 2
  s_cmp_le_u32 s84, 32
  s_cbranch_scc1 L_fsl_86
L_fok_85:
  v_mfma_f32_16x16x32_bf16 v[56:59], a[24:27], v[32:35], v[56:59]
  ds_read_b64_tr_b16 a[0:1], v5 offset:32768
  v_mfma_f32_16x16x32_bf16 v[60:63], a[28:31], v[32:35], v[60:63]
  s_waitcnt vmcnt(9)
  v_mfma_f32_16x16x32_bf16 v[64:67], a[16:19], v[36:39], v[64:67]
  s_add_u32 s51, s94, s44
  buffer_load_dwordx4 v[32:35], v4, s[36:39], s51 offen sc1
  s_add_u32 s44, s44, 1024
  s_cmp_eq_u32 s44, 14336
  s_cselect_b32 s44, 0, s44
  ds_read_b64_tr_b16 a[2:3], v5 offset:33280
  v_mfma_f32_16x16x32_bf16 v[68:71], a[20:23], v[36:39], v[68:71]
  ds_read_b64_tr_b16 a[4:5], v5 offset:32776
  v_mfma_f32_16x16x32_bf16 v[72:75], a[24:27], v[36:39], v[72:75]
  v_mfma_f32_16x16x32_bf16 v[76:79], a[28:31], v[36:39], v[76:79]
  ds_read_b64_tr_b16 a[6:7], v5 offset:33288
  s_waitcnt vmcnt(9)
  v_mfma_f32_16x16x32_bf16 v[80:83], a[16:19], v[40:43], v[80:83]
  s_add_u32 s51, s91, s44
  buffer_load_dwordx4 v[36:39], v4, s[36:39], s51 offen sc1
  ds_read_b64_tr_b16 a[8:9], v6 offset:32768
  v_mfma_f32_16x16x32_bf16 v[84:87], a[20:23], v[40:43], v[84:87]
  v_mfma_f32_16x16x32_bf16 v[88:91], a[24:27], v[40:43], v[88:91]
  ds_read_b64_tr_b16 a[10:11], v6 offset:33280
  v_mfma_f32_16x16x32_bf16 v[92:95], a[28:31], v[40:43], v[92:95]
  ds_read_b64_tr_b16 a[12:13], v6 offset:32776
  s_waitcnt vmcnt(9)
  v_mfma_f32_16x16x32_bf16 v[96:99], a[16:19], v[44:47], v[96:99]
  s_add_u32 s51, s92, s44
  buffer_load_dwordx4 v[40:43], v4, s[36:39], s51 offen sc1
  v_mfma_f32_16x16x32_bf16 v[100:103], a[20:23], v[44:47], v[100:103]
  ds_read_b64_tr_b16 a[14:15], v6 offset:33288
  v_mfma_f32_16x16x32_bf16 v[104:107], a[24:27], v[44:47], v[104:107]
  ds_read_b32 v125, v126
  v_mfma_f32_16x16x32_bf16 v[108:111], a[28:31], v[44:47], v[108:111]
  s_waitcnt vmcnt(9)
  v_mfma_f32_16x16x32_bf16 v[48:51], a[32:35], v[112:115], v[48:51]
  s_add_u32 s51, s93, s44
  buffer_load_dwordx4 v[44:47], v4, s[36:39], s51 offen sc1
  s_waitcnt lgkmcnt(1)
  v_mov_b32 v13, 33
  ds_write_b32 v126, v13 offset:16
  v_mfma_f32_16x16x32_bf16 v[52:55], a[36:39], v[112:115], v[52:55]
  s_waitcnt lgkmcnt(1)
  v_readfirstlane_b32 s84, v125
  v_mfma_f32_16x16x32_bf16 v[56:59], a[40:43], v[112:115], v[56:59]
  s_nop 2
  s_cmp_le_u32 s84, 33
  s_cbranch_scc1 L_fsl_88
L_fok_87:
  v_mfma_f32_16x16x32_bf16 v[60:63], a[44:47], v[112:115], v[60:63]
  s_waitcnt vmcnt(9)
  v_mfma_f32_16x16x32_bf16 v[64:67], a[32:35], v[116:119], v[64:67]
  s_add_u32 s51, s94, s44
  buffer_load_dwordx4 v[112:115], v4, s[36:39], s51 offen sc1
  s_add_u32 s44, s44, 1024
  s_cmp_eq_u32 s44, 14336
  s_cselect_b32 s44, 0, s44
  ds_read_b64_tr_b16 a[16:17], v5 offset:49152
  v_mfma_f32_16x16x32_bf16 v[68:71], a[36:39], v[116:119], v[68:71]
  ds_read_b64_tr_b16 a[18:19], v5 offset:49664
  v_mfma_f32_16x16x32_bf16 v[72:75], a[40:43], v[116:119], v[72:75]
  ds_read_b64_tr_b16 a[20:21], v5 offset:49160
  v_mfma_f32_16x16x32_bf16 v[76:79], a[44:47], v[116:119], v[76:79]
  s_waitcnt vmcnt(9)
  v_mfma_f32_16x16x32_bf16 v[80:83], a[32:35], v[120:123], v[80:83]
  s_add_u32 s51, s91, s44
  buffer_load_dwordx4 v[116:119], v4, s[36:39], s51 offen sc1
  ds_read_b64_tr_b16 a[22:23], v5 offset:49672
  v_mfma_f32_16x16x32_bf16 v[84:87], a[36:39], v[120:123], v[84:87]
  ds_read_b64_tr_b16 a[24:25], v6 offset:49152
  v_mfma_f32_16x16x32_bf16 v[88:91], a[40:43], v[120:123], v[88:91]
  ds_read_b64_tr_b16 a[26:27], v6 offset:49664
  v_mfma_f32_16x16x32_bf16 v[92:95], a[44:47], v[120:123], v[92:95]
  s_waitcnt vmcnt(9)
  v_mfma_f32_16x16x32_bf16 v[96:99], a[32:35], v[16:19], v[96:99]
  s_add_u32 s51, s92, s44
  buffer_load_dwordx4 v[120:123], v4, s[36:39], s51 offen sc1
  ds_read_b64_tr_b16 a[28:29], v6 offset:49160
  v_mfma_f32_16x16x32_bf16 v[100:103], a[36:39], v[16:19], v[100:103]
  ds_read_b64_tr_b16 a[30:31], v6 offset:49672
  v_mfma_f32_16x16x32_bf16 v[104:107], a[40:43], v[16:19], v[104:107]
  ds_read_b32 v125, v126
  v_mfma_f32_16x16x32_bf16 v[108:111], a[44:47], v[16:19], v[108:111]
  s_waitcnt vmcnt(9)
  v_mfma_f32_16x16x32_bf16 v[48:51], a[48:51], v[20:23], v[48:51]
  s_add_u32 s51, s93, s44
  buffer_load_dwordx4 v[16:19], v4, s[36:39], s51 offen sc1
  s_waitcnt lgkmcnt(1)
  v_mov_b32 v13, 34
  ds_write_b32 v126, v13 offset:16
  v_mfma_f32_16x16x32_bf16 v[52:55], a[52:55], v[20:23], v[52:55]
  s_waitcnt lgkmcnt(1)
  v_readfirstlane_b32 s84, v125
  v_mfma_f32_16x16x32_bf16 v[56:59], a[56:59], v[20:23], v[56:59]
  s_nop 2
  s_cmp_le_u32 s84, 34
  s_cbranch_scc1 L_fsl_90
L_fok_89:
  v_mfma_f32_16x16x32_bf16 v[60:63], a[60:63], v[20:23], v[60:63]
  s_waitcnt vmcnt(9)
  v_mfma_f32_16x16x32_bf16 v[64:67], a[48:51], v[24:27], v[64:67]
  s_add_u32 s51, s94, s44
  buffer_load_dwordx4 v[20:23], v4, s[36:39], s51 offen sc1
  s_add_u32 s44, s44, 1024
  s_cmp_eq_u32 s44, 14336
  s_cselect_b32 s44, 0, s44
  ds_read_b64_tr_b16 a[32:33], v15 offset:49152
  v_mfma_f32_16x16x32_bf16 v[68:71], a[52:55], v[24:27], v[68:71]
  ds_read_b64_tr_b16 a[34:35], v15 offset:49664
  v_mfma_f32_16x16x32_bf16 v[72:75], a[56:59], v[24:27], v[72:75]
  ds_read_b64_tr_b16 a[36:37], v15 offset:49160
  v_mfma_f32_16x16x32_bf16 v[76:79], a[60:63], v[24:27], v[76:79]
  s_waitcnt vmcnt(9)
  v_mfma_f32_16x16x32_bf16 v[80:83], a[48:51], v[28:31], v[80:83]
  s_add_u32 s51, s91, s44
  buffer_load_dwordx4 v[24:27], v4, s[36:39], s51 offen sc1
  ds_read_b64_tr_b16 a[38:39], v15 offset:49672
  v_mfma_f32_16x16x32_bf16 v[84:87], a[52:55], v[28:31], v[84:87]
  ds_read_b64_tr_b16 a[40:41], v124 offset:49152
  v_mfma_f32_16x16x32_bf16 v[88:91], a[56:59], v[28:31], v[88:91]
  ds_read_b64_tr_b16 a[42:43], v124 offset:49664
  v_mfma_f32_16x16x32_bf16 v[92:95], a[60:63], v[28:31], v[92:95]
  s_waitcnt vmcnt(9)
  v_mfma_f32_16x16x32_bf16 v[96:99], a[48:51], v[32:35], v[96:99]
  s_add_u32 s51, s92, s44
  buffer_load_dwordx4 v[28:31], v4, s[36:39], s51 offen sc1
  ds_read_b64_tr_b16 a[44:45], v124 offset:49160
  v_mfma_f32_16x16x32_bf16 v[100:103], a[52:55], v[32:35], v[100:103]
  ds_read_b64_tr_b16 a[46:47], v124 offset:49672
  v_mfma_f32_16x16x32_bf16 v[104:107], a[56:59], v[32:35], v[104:107]
  ds_read_b32 v125, v126
  v_mfma_f32_16x16x32_bf16 v[108:111], a[60:63], v[32:35], v[108:111]
  s_waitcnt vmcnt(9)
  v_mfma_f32_16x16x32_bf16 v[48:51], a[64:67], v[36:39], v[48:51]
  s_add_u32 s51, s93, s44
  buffer_load_dwordx4 v[32:35], v4, s[36:39], s51 offen sc1
  s_waitcnt lgkmcnt(1)
  v_mov_b32 v13, 35
  ds_write_b32 v126, v13 offset:16
  v_mfma_f32_16x16x32_bf16 v[52:55], a[68:71], v[36:39], v[52:55]
  s_waitcnt lgkmcnt(1)
  v_readfirstlane_b32 s84, v125
  v_mfma_f32_16x16x32_bf16 v[56:59], a[72:75], v[36:39], v[56:59]
  s_nop 2
  s_cmp_le_u32 s84, 35
  s_cbranch_scc1 L_fsl_92
L_fok_91:
  v_mfma_f32_16x16x32_bf16 v[60:63], a[76:79], v[36:39], v[60:63]
  s_waitcnt vmcnt(9)
  v_mfma_f32_16x16x32_bf16 v[64:67], a[64:67], v[40:43], v[64:67]
  s_add_u32 s51, s94, s44
  buffer_load_dwordx4 v[36:39], v4, s[36:39], s51 offen sc1
  s_add_u32 s44, s44, 1024
  s_cmp_eq_u32 s44, 14336
  s_cselect_b32 s44, 0, s44
  ds_read_b64_tr_b16 a[48:49], v5 offset:0
  v_mfma_f32_16x16x32_bf16 v[68:71], a[68:71], v[40:43], v[68:71]
  ds_read_b64_tr_b16 a[50:51], v5 offset:512
  v_mfma_f32_16x16x32_bf16 v[72:75], a[72:75], v[40:43], v[72:75]
  ds_read_b64_tr_b16 a[52:53], v5 offset:8
  v_mfma_f32_16x16x32_bf16 v[76:79], a[76:79], v[40:43], v[76:79]
  s_waitcnt vmcnt(9)
  v_mfma_f32_16x16x32_bf16 v[80:83], a[64:67], v[44:47], v[80:83]
  s_add_u32 s51, s91, s44
  buffer_load_dwordx4 v[40:43], v4, s[36:39], s51 offen sc1
  ds_read_b64_tr_b16 a[54:55], v5 offset:520
  v_mfma_f32_16x16x32_bf16 v[84:87], a[68:71], v[44:47], v[84:87]
  ds_read_b64_tr_b16 a[56:57], v6 offset:0
  v_mfma_f32_16x16x32_bf16 v[88:91], a[72:75], v[44:47], v[88:91]
  ds_read_b64_tr_b16 a[58:59], v6 offset:512
  v_mfma_f32_16x16x32_bf16 v[92:95], a[76:79], v[44:47], v[92:95]
  s_waitcnt vmcnt(9)
  v_mfma_f32_16x16x32_bf16 v[96:99], a[64:67], v[112:115], v[96:99]
  s_add_u32 s51, s92, s44
  buffer_load_dwordx4 v[44:47], v4, s[36:39], s51 offen sc1
  ds_read_b64_tr_b16 a[60:61], v6 offset:8
  v_mfma_f32_16x16x32_bf16 v[100:103], a[68:71], v[112:115], v[100:103]
  ds_read_b64_tr_b16 a[62:63], v6 offset:520
  v_mfma_f32_16x16x32_bf16 v[104:107], a[72:75], v[112:115], v[104:107]
  ds_read_b32 v125, v126
  v_mfma_f32_16x16x32_bf16 v[108:111], a[76:79], v[112:115], v[108:111]
  s_waitcnt vmcnt(9)
  v_mfma_f32_16x16x32_bf16 v[48:51], a[80:83], v[116:119], v[48:51]
  s_add_u32 s51, s93, s44
  buffer_load_dwordx4 v[112:115], v4, s[36:39], s51 offen sc1
  s_waitcnt lgkmcnt(1)
  v_mov_b32 v13, 36
  ds_write_b32 v126, v13 offset:16
  v_mfma_f32_16x16x32_bf16 v[52:55], a[84:87], v[116:119], v[52:55]
  s_waitcnt lgkmcnt(1)
  v_readfirstlane_b32 s84, v125
  v_mfma_f32_16x16x32_bf16 v[56:59], a[88:91], v[116:119], v[56:59]
  s_nop 2
  s_cmp_le_u32 s84, 36
  s_cbranch_scc1 L_fsl_94
L_fok_93:
  v_mfma_f32_16x16x32_bf16 v[60:63], a[92:95], v[116:119], v[60:63]
  s_waitcnt vmcnt(9)
  v_mfma_f32_16x16x32_bf16 v[64:67], a[80:83], v[120:123], v[64:67]
  s_add_u32 s51, s94, s44
  buffer_load_dwordx4 v[116:119], v4, s[36:39], s51 offen sc1
  s_add_u32 s44, s44, 1024
  s_cmp_eq_u32 s44, 14336
  s_cselect_b32 s44, 0, s44
  ds_read_b64_tr_b16 a[64:65], v5 offset:16384
  v_mfma_f32_16x16x32_bf16 v[68:71], a[84:87], v[120:123], v[68:71]
  ds_read_b64_tr_b16 a[66:67], v5 offset:16896
  v_mfma_f32_16x16x32_bf16 v[72:75], a[88:91], v[120:123], v[72:75]
  ds_read_b64_tr_b16 a[68:69], v5 offset:16392
  v_mfma_f32_16x16x32_bf16 v[76:79], a[92:95], v[120:123], v[76:79]
  s_waitcnt vmcnt(9)
  v_mfma_f32_16x16x32_bf16 v[80:83], a[80:83], v[16:19], v[80:83]
  s_add_u32 s51, s91, s44
  buffer_load_dwordx4 v[120:123], v4, s[36:39], s51 offen sc1
  ds_read_b64_tr_b16 a[70:71], v5 offset:16904
  v_mfma_f32_16x16x32_bf16 v[84:87], a[84:87], v[16:19], v[84:87]
  ds_read_b64_tr_b16 a[72:73], v6 offset:16384
  v_mfma_f32_16x16x32_bf16 v[88:91], a[88:91], v[16:19], v[88:91]
  ds_read_b64_tr_b16 a[74:75], v6 offset:16896
  v_mfma_f32_16x16x32_bf16 v[92:95], a[92:95], v[16:19], v[92:95]
  s_waitcnt vmcnt(9)
  v_mfma_f32_16x16x32_bf16 v[96:99], a[80:83], v[20:23], v[96:99]
  s_add_u32 s51, s92, s44
  buffer_load_dwordx4 v[16:19], v4, s[36:39], s51 offen sc1
  ds_read_b64_tr_b16 a[76:77], v6 offset:16392
  v_mfma_f32_16x16x32_bf16 v[100:103], a[84:87], v[20:23], v[100:103]
  ds_read_b64_tr_b16 a[78:79], v6 offset:16904
  v_mfma_f32_16x16x32_bf16 v[104:107], a[88:91], v[20:23], v[104:107]
  ds_read_b32 v125, v126
  v_mfma_f32_16x16x32_bf16 v[108:111], a[92:95], v[20:23], v[108:111]
  s_waitcnt vmcnt(9)
  v_mfma_f32_16x16x32_bf16 v[48:51], a[96:99], v[24:27], v[48:51]
  s_add_u32 s51, s93, s44
  buffer_load_dwordx4 v[20:23], v4, s[36:39], s51 offen sc1
  s_waitcnt lgkmcnt(1)
  v_mov_b32 v13, 37
  ds_write_b32 v126, v13 offset:16
  v_mfma_f32_16x16x32_bf16 v[52:55], a[100:103], v[24:27], v[52:55]
  s_waitcnt lgkmcnt(1)
  v_readfirstlane_b32 s84, v125
  v_mfma_f32_16x16x32_bf16 v[56:59], a[104:107], v[24:27], v[56:59]
  s_nop 2
  s_cmp_le_u32 s84, 37
  s_cbranch_scc1 L_fsl_96
L_fok_95:
  v_mfma_f32_16x16x32_bf16 v[60:63], a[108:111], v[24:27], v[60:63]
  s_waitcnt vmcnt(9)
  v_mfma_f32_16x16x32_bf16 v[64:67], a[96:99], v[28:31], v[64:67]
  s_add_u32 s51, s94, s44
  buffer_load_dwordx4 v[24:27], v4, s[36:39], s51 offen sc1
  s_add_u32 s44, s44, 1024
  s_cmp_eq_u32 s44, 14336
  s_cselect_b32 s44, 0, s44
  ds_read_b64_tr_b16 a[80:81], v5 offset:32768
  v_mfma_f32_16x16x32_bf16 v[68:71], a[100:103], v[28:31], v[68:71]
  ds_read_b64_tr_b16 a[82:83], v5 offset:33280
  v_mfma_f32_16x16x32_bf16 v[72:75], a[104:107], v[28:31], v[72:75]
  ds_read_b64_tr_b16 a[84:85], v5 offset:32776
  v_mfma_f32_16x16x32_bf16 v[76:79], a[108:111], v[28:31], v[76:79]
  s_waitcnt vmcnt(9)
  v_mfma_f32_16x16x32_bf16 v[80:83], a[96:99], v[32:35], v[80:83]
  s_add_u32 s51, s91, s44
  buffer_load_dwordx4 v[28:31], v4, s[36:39], s51 offen sc1
  ds_read_b64_tr_b16 a[86:87], v5 offset:33288
  v_mfma_f32_16x16x32_bf16 v[84:87], a[100:103], v[32:35], v[84:87]
  ds_read_b64_tr_b16 a[88:89], v6 offset:32768
  v_mfma_f32_16x16x32_bf16 v[88:91], a[104:107], v[32:35], v[88:91]
  ds_read_b64_tr_b16 a[90:91], v6 offset:33280
  v_mfma_f32_16x16x32_bf16 v[92:95], a[108:111], v[32:35], v[92:95]
  s_waitcnt vmcnt(9)
  v_mfma_f32_16x16x32_bf16 v[96:99], a[96:99], v[36:39], v[96:99]
  s_add_u32 s51, s92, s44
  buffer_load_dwordx4 v[32:35], v4, s[36:39], s51 offen sc1
  ds_read_b64_tr_b16 a[92:93], v6 offset:32776
  v_mfma_f32_16x16x32_bf16 v[100:103], a[100:103], v[36:39], v[100:103]
  ds_read_b64_tr_b16 a[94:95], v6 offset:33288
  v_mfma_f32_16x16x32_bf16 v[104:107], a[104:107], v[36:39], v[104:107]
  ds_read_b32 v125, v126
  v_mfma_f32_16x16x32_bf16 v[108:111], a[108:111], v[36:39], v[108:111]
  s_waitcnt vmcnt(9)
  v_mfma_f32_16x16x32_bf16 v[48:51], a[112:115], v[40:43], v[48:51]
  s_add_u32 s51, s93, s44
  buffer_load_dwordx4 v[36:39], v4, s[36:39], s51 offen sc1
  v_mfma_f32_16x16x32_bf16 v[52:55], a[116:119], v[40:43], v[52:55]
  v_mfma_f32_16x16x32_bf16 v[56:59], a[120:123], v[40:43], v[56:59]
  v_mfma_f32_16x16x32_bf16 v[60:63], a[124:127], v[40:43], v[60:63]
  s_waitcnt vmcnt(9)
  v_mfma_f32_16x16x32_bf16 v[64:67], a[112:115], v[44:47], v[64:67]
  s_add_u32 s51, s94, s44
  buffer_load_dwordx4 v[40:43], v4, s[36:39], s51 offen sc1
  s_add_u32 s44, s44, 1024
  s_cmp_eq_u32 s44, 14336
  s_cselect_b32 s44, 0, s44
  v_mfma_f32_16x16x32_bf16 v[68:71], a[116:119], v[44:47], v[68:71]
  v_mfma_f32_16x16x32_bf16 v[72:75], a[120:123], v[44:47], v[72:75]
  v_mfma_f32_16x16x32_bf16 v[76:79], a[124:127], v[44:47], v[76:79]
  s_waitcnt vmcnt(9)
  v_mfma_f32_16x16x32_bf16 v[80:83], a[112:115], v[112:115], v[80:83]
  s_add_u32 s51, s91, s44
  buffer_load_dwordx4 v[44:47], v4, s[36:39], s51 offen sc1
  v_mfma_f32_16x16x32_bf16 v[84:87], a[116:119], v[112:115], v[84:87]
  v_mfma_f32_16x16x32_bf16 v[88:91], a[120:123], v[112:115], v[88:91]
  v_mfma_f32_16x16x32_bf16 v[92:95], a[124:127], v[112:115], v[92:95]
  s_waitcnt vmcnt(9)
  v_mfma_f32_16x16x32_bf16 v[96:99], a[112:115], v[116:119], v[96:99]
  s_add_u32 s51, s92, s44
  buffer_load_dwordx4 v[112:115], v4, s[36:39], s51 offen sc1
  v_mfma_f32_16x16x32_bf16 v[100:103], a[116:119], v[116:119], v[100:103]
  v_mfma_f32_16x16x32_bf16 v[104:107], a[120:123], v[116:119], v[104:107]
  v_mfma_f32_16x16x32_bf16 v[108:111], a[124:127], v[116:119], v[108:111]
  s_waitcnt lgkmcnt(0)
  s_waitcnt lgkmcnt(0)
  s_waitcnt vmcnt(9)
  v_mfma_f32_16x16x32_bf16 v[48:51], a[0:3], v[120:123], v[48:51]
  s_add_u32 s51, s93, s44
  buffer_load_dwordx4 v[116:119], v4, s[36:39], s51 offen sc1
  v_mfma_f32_16x16x32_bf16 v[52:55], a[4:7], v[120:123], v[52:55]
  v_mfma_f32_16x16x32_bf16 v[56:59], a[8:11], v[120:123], v[56:59]
  v_mfma_f32_16x16x32_bf16 v[60:63], a[12:15], v[120:123], v[60:63]
  s_waitcnt vmcnt(9)
  v_mfma_f32_16x16x32_bf16 v[64:67], a[0:3], v[16:19], v[64:67]
  s_add_u32 s51, s94, s44
  buffer_load_dwordx4 v[120:123], v4, s[36:39], s51 offen sc1
  s_add_u32 s44, s44, 1024
  s_cmp_eq_u32 s44, 14336
  s_cselect_b32 s44, 0, s44
  v_mfma_f32_16x16x32_bf16 v[68:71], a[4:7], v[16:19], v[68:71]
  v_mfma_f32_16x16x32_bf16 v[72:75], a[8:11], v[16:19], v[72:75]
  v_mfma_f32_16x16x32_bf16 v[76:79], a[12:15], v[16:19], v[76:79]
  s_waitcnt vmcnt(9)
  v_mfma_f32_16x16x32_bf16 v[80:83], a[0:3], v[20:23], v[80:83]
  s_add_u32 s51, s91, s44
  buffer_load_dwordx4 v[16:19], v4, s[36:39], s51 offen sc1
  v_mfma_f32_16x16x32_bf16 v[84:87], a[4:7], v[20:23], v[84:87]
  v_mfma_f32_16x16x32_bf16 v[88:91], a[8:11], v[20:23], v[88:91]
  v_mfma_f32_16x16x32_bf16 v[92:95], a[12:15], v[20:23], v[92:95]
  s_waitcnt vmcnt(9)
  v_mfma_f32_16x16x32_bf16 v[96:99], a[0:3], v[24:27], v[96:99]
  s_add_u32 s51, s92, s44
  buffer_load_dwordx4 v[20:23], v4, s[36:39], s51 offen sc1
  v_mfma_f32_16x16x32_bf16 v[100:103], a[4:7], v[24:27], v[100:103]
  v_mfma_f32_16x16x32_bf16 v[104:107], a[8:11], v[24:27], v[104:107]
  v_mfma_f32_16x16x32_bf16 v[108:111], a[12:15], v[24:27], v[108:111]
  s_waitcnt vmcnt(9)
  v_mfma_f32_16x16x32_bf16 v[48:51], a[16:19], v[28:31], v[48:51]
  s_add_u32 s51, s93, s44
  buffer_load_dwordx4 v[24:27], v4, s[36:39], s51 offen sc1
  v_mfma_f32_16x16x32_bf16 v[52:55], a[20:23], v[28:31], v[52:55]
  v_mfma_f32_16x16x32_bf16 v[56:59], a[24:27], v[28:31], v[56:59]
  v_mfma_f32_16x16x32_bf16 v[60:63], a[28:31], v[28:31], v[60:63]
  s_waitcnt vmcnt(9)
  v_mfma_f32_16x16x32_bf16 v[64:67], a[16:19], v[32:35], v[64:67]
  s_add_u32 s51, s94, s44
  buffer_load_dwordx4 v[28:31], v4, s[36:39], s51 offen sc1
  s_add_u32 s44, s44, 1024
  s_cmp_eq_u32 s44, 14336
  s_cselect_b32 s44, 0, s44
  v_mfma_f32_16x16x32_bf16 v[68:71], a[20:23], v[32:35], v[68:71]
  v_mfma_f32_16x16x32_bf16 v[72:75], a[24:27], v[32:35], v[72:75]
  v_mfma_f32_16x16x32_bf16 v[76:79], a[28:31], v[32:35], v[76:79]
  s_waitcnt vmcnt(9)
  v_mfma_f32_16x16x32_bf16 v[80:83], a[16:19], v[36:39], v[80:83]
  s_add_u32 s51, s91, s44
  buffer_load_dwordx4 v[32:35], v4, s[36:39], s51 offen sc1
  v_mfma_f32_16x16x32_bf16 v[84:87], a[20:23], v[36:39], v[84:87]
  v_mfma_f32_16x16x32_bf16 v[88:91], a[24:27], v[36:39], v[88:91]
  v_mfma_f32_16x16x32_bf16 v[92:95], a[28:31], v[36:39], v[92:95]
  s_waitcnt vmcnt(9)
  v_mfma_f32_16x16x32_bf16 v[96:99], a[16:19], v[40:43], v[96:99]
  s_add_u32 s51, s92, s44
  buffer_load_dwordx4 v[36:39], v4, s[36:39], s51 offen sc1
  v_mfma_f32_16x16x32_bf16 v[100:103], a[20:23], v[40:43], v[100:103]
  v_mfma_f32_16x16x32_bf16 v[104:107], a[24:27], v[40:43], v[104:107]
  v_mfma_f32_16x16x32_bf16 v[108:111], a[28:31], v[40:43], v[108:111]
  s_waitcnt vmcnt(9)
  v_mfma_f32_16x16x32_bf16 v[48:51], a[32:35], v[44:47], v[48:51]
  s_add_u32 s51, s93, s44
  buffer_load_dwordx4 v[40:43], v4, s[36:39], s51 offen sc1
  v_mfma_f32_16x16x32_bf16 v[52:55], a[36:39], v[44:47], v[52:55]
  v_mfma_f32_16x16x32_bf16 v[56:59], a[40:43], v[44:47], v[56:59]
  v_mfma_f32_16x16x32_bf16 v[60:63], a[44:47], v[44:47], v[60:63]
  s_waitcnt vmcnt(9)
  v_mfma_f32_16x16x32_bf16 v[64:67], a[32:35], v[112:115], v[64:67]
  s_add_u32 s51, s94, s44
  buffer_load_dwordx4 v[44:47], v4, s[36:39], s51 offen sc1
  s_add_u32 s44, s44, 1024
  s_cmp_eq_u32 s44, 14336
  s_cselect_b32 s44, 0, s44
  v_mfma_f32_16x16x32_bf16 v[68:71], a[36:39], v[112:115], v[68:71]
  v_mfma_f32_16x16x32_bf16 v[72:75], a[40:43], v[112:115], v[72:75]
  v_mfma_f32_16x16x32_bf16 v[76:79], a[44:47], v[112:115], v[76:79]
  s_waitcnt vmcnt(9)
  v_mfma_f32_16x16x32_bf16 v[80:83], a[32:35], v[116:119], v[80:83]
  s_add_u32 s51, s91, s44
  buffer_load_dwordx4 v[112:115], v4, s[36:39], s51 offen sc1
  v_mfma_f32_16x16x32_bf16 v[84:87], a[36:39], v[116:119], v[84:87]
  v_mfma_f32_16x16x32_bf16 v[88:91], a[40:43], v[116:119], v[88:91]
  v_mfma_f32_16x16x32_bf16 v[92:95], a[44:47], v[116:119], v[92:95]
  s_waitcnt vmcnt(9)
  v_mfma_f32_16x16x32_bf16 v[96:99], a[32:35], v[120:123], v[96:99]
  s_add_u32 s51, s92, s44
  buffer_load_dwordx4 v[116:119], v4, s[36:39], s51 offen sc1
  v_mfma_f32_16x16x32_bf16 v[100:103], a[36:39], v[120:123], v[100:103]
  v_mfma_f32_16x16x32_bf16 v[104:107], a[40:43], v[120:123], v[104:107]
  v_mfma_f32_16x16x32_bf16 v[108:111], a[44:47], v[120:123], v[108:111]
  s_waitcnt vmcnt(9)
  v_mfma_f32_16x16x32_bf16 v[48:51], a[48:51], v[16:19], v[48:51]
  s_add_u32 s51, s93, s44
  buffer_load_dwordx4 v[120:123], v4, s[36:39], s51 offen sc1
  v_mfma_f32_16x16x32_bf16 v[52:55], a[52:55], v[16:19], v[52:55]
  v_mfma_f32_16x16x32_bf16 v[56:59], a[56:59], v[16:19], v[56:59]
  v_mfma_f32_16x16x32_bf16 v[60:63], a[60:63], v[16:19], v[60:63]
  s_waitcnt vmcnt(9)
  v_mfma_f32_16x16x32_bf16 v[64:67], a[48:51], v[20:23], v[64:67]
  s_add_u32 s51, s94, s44
  buffer_load_dwordx4 v[16:19], v4, s[36:39], s51 offen sc1
  s_add_u32 s44, s44, 1024
  s_cmp_eq_u32 s44, 14336
  s_cselect_b32 s44, 0, s44
  v_mfma_f32_16x16x32_bf16 v[68:71], a[52:55], v[20:23], v[68:71]
  v_mfma_f32_16x16x32_bf16 v[72:75], a[56:59], v[20:23], v[72:75]
  v_mfma_f32_16x16x32_bf16 v[76:79], a[60:63], v[20:23], v[76:79]
  s_waitcnt vmcnt(9)
  v_mfma_f32_16x16x32_bf16 v[80:83], a[48:51], v[24:27], v[80:83]
  v_mfma_f32_16x16x32_bf16 v[84:87], a[52:55], v[24:27], v[84:87]
  v_mfma_f32_16x16x32_bf16 v[88:91], a[56:59], v[24:27], v[88:91]
  v_mfma_f32_16x16x32_bf16 v[92:95], a[60:63], v[24:27], v[92:95]
  s_waitcnt vmcnt(8)
  v_mfma_f32_16x16x32_bf16 v[96:99], a[48:51], v[28:31], v[96:99]
  v_mfma_f32_16x16x32_bf16 v[100:103], a[52:55], v[28:31], v[100:103]
  v_mfma_f32_16x16x32_bf16 v[104:107], a[56:59], v[28:31], v[104:107]
  v_mfma_f32_16x16x32_bf16 v[108:111], a[60:63], v[28:31], v[108:111]
  s_waitcnt vmcnt(7)
  v_mfma_f32_16x16x32_bf16 v[48:51], a[64:67], v[32:35], v[48:51]
  v_mfma_f32_16x16x32_bf16 v[52:55], a[68:71], v[32:35], v[52:55]
  v_mfma_f32_16x16x32_bf16 v[56:59], a[72:75], v[32:35], v[56:59]
  v_mfma_f32_16x16x32_bf16 v[60:63], a[76:79], v[32:35], v[60:63]
  s_waitcnt vmcnt(6)
  v_mfma_f32_16x16x32_bf16 v[64:67], a[64:67], v[36:39], v[64:67]
  v_mfma_f32_16x16x32_bf16 v[68:71], a[68:71], v[36:39], v[68:71]
  v_mfma_f32_16x16x32_bf16 v[72:75], a[72:75], v[36:39], v[72:75]
  v_mfma_f32_16x16x32_bf16 v[76:79], a[76:79], v[36:39], v[76:79]
  s_waitcnt vmcnt(5)
  v_mfma_f32_16x16x32_bf16 v[80:83], a[64:67], v[40:43], v[80:83]
  v_mfma_f32_16x16x32_bf16 v[84:87], a[68:71], v[40:43], v[84:87]
  v_mfma_f32_16x16x32_bf16 v[88:91], a[72:75], v[40:43], v[88:91]
  v_mfma_f32_16x16x32_bf16 v[92:95], a[76:79], v[40:43], v[92:95]
  s_waitcnt vmcnt(4)
  v_mfma_f32_16x16x32_bf16 v[96:99], a[64:67], v[44:47], v[96:99]
  v_mfma_f32_16x16x32_bf16 v[100:103], a[68:71], v[44:47], v[100:103]
  v_mfma_f32_16x16x32_bf16 v[104:107], a[72:75], v[44:47], v[104:107]
  v_mfma_f32_16x16x32_bf16 v[108:111], a[76:79], v[44:47], v[108:111]
  s_waitcnt vmcnt(3)
  v_mfma_f32_16x16x32_bf16 v[48:51], a[80:83], v[112:115], v[48:51]
  v_mfma_f32_16x16x32_bf16 v[52:55], a[84:87], v[112:115], v[52:55]
  v_mfma_f32_16x16x32_bf16 v[56:59], a[88:91], v[112:115], v[56:59]
  v_mfma_f32_16x16x32_bf16 v[60:63], a[92:95], v[112:115], v[60:63]
  s_waitcnt vmcnt(2)
  v_mfma_f32_16x16x32_bf16 v[64:67], a[80:83], v[116:119], v[64:67]
  v_mfma_f32_16x16x32_bf16 v[68:71], a[84:87], v[116:119], v[68:71]
  v_mfma_f32_16x16x32_bf16 v[72:75], a[88:91], v[116:119], v[72:75]
  v_mfma_f32_16x16x32_bf16 v[76:79], a[92:95], v[116:119], v[76:79]
  s_waitcnt vmcnt(1)
  v_mfma_f32_16x16x32_bf16 v[80:83], a[80:83], v[120:123], v[80:83]
  v_mfma_f32_16x16x32_bf16 v[84:87], a[84:87], v[120:123], v[84:87]
  v_mfma_f32_16x16x32_bf16 v[88:91], a[88:91], v[120:123], v[88:91]
  v_mfma_f32_16x16x32_bf16 v[92:95], a[92:95], v[120:123], v[92:95]
  s_waitcnt vmcnt(0)
  v_mfma_f32_16x16x32_bf16 v[96:99], a[80:83], v[16:19], v[96:99]
  v_mfma_f32_16x16x32_bf16 v[100:103], a[84:87], v[16:19], v[100:103]
  v_mfma_f32_16x16x32_bf16 v[104:107], a[88:91], v[16:19], v[104:107]
  v_mfma_f32_16x16x32_bf16 v[108:111], a[92:95], v[16:19], v[108:111]
  s_lshl_b32 s48, s42, 14
  s_lshl_b32 s49, s41, 11
  s_add_u32 s48, s48, s49
  s_add_u32 s48, s48, s53
  s_add_u32 s48, s48, 4194304
  buffer_load_dwordx4 v[16:19], v4, s[36:39], s48 offen sc1
  buffer_load_dwordx4 v[20:23], v4, s[36:39], s48 offen offset:1024 sc1
  s_barrier
  s_sub_u32 s48, s42, 1
  s_and_b32 s48, s48, 3
  s_lshl_b32 s48, s48, 12
  s_add_u32 s48, s48, 81920
  v_add_u32 v9, s48, v4
  ds_write_b128 v9, v[48:51] offset:0
  ds_write_b128 v9, v[52:55] offset:1024
  ds_write_b128 v9, v[56:59] offset:2048
  ds_write_b128 v9, v[60:63] offset:3072
  s_sub_u32 s48, s42, 2
  s_and_b32 s48, s48, 3
  s_lshl_b32 s48, s48, 12
  s_add_u32 s48, s48, 98304
  v_add_u32 v9, s48, v4
  ds_write_b128 v9, v[64:67] offset:0
  ds_write_b128 v9, v[68:71] offset:1024
  ds_write_b128 v9, v[72:75] offset:2048
  ds_write_b128 v9, v[76:79] offset:3072
  s_sub_u32 s48, s42, 3
  s_and_b32 s48, s48, 3
  s_lshl_b32 s48, s48, 12
  s_add_u32 s48, s48, 114688
  v_add_u32 v9, s48, v4
  ds_write_b128 v9, v[80:83] offset:0
  ds_write_b128 v9, v[84:87] offset:1024
  ds_write_b128 v9, v[88:91] offset:2048
  ds_write_b128 v9, v[92:95] offset:3072
  s_sub_u32 s48, s42, 4
  s_and_b32 s48, s48, 3
  s_lshl_b32 s48, s48, 12
  s_add_u32 s48, s48, 131072
  v_add_u32 v9, s48, v4
  ds_write_b128 v9, v[96:99] offset:0
  ds_write_b128 v9, v[100:103] offset:1024
  ds_write_b128 v9, v[104:107] offset:2048
  ds_write_b128 v9, v[108:111] offset:3072
  s_waitcnt lgkmcnt(0)
  s_barrier
  s_lshl_b32 s48, s42, 14
  s_add_u32 s48, s48, 81920
  v_add_u32 v9, s48, v4
  ds_read_b128 v[48:51], v9 offset:0
  ds_read_b128 v[52:55], v9 offset:1024
  ds_read_b128 v[56:59], v9 offset:2048
  ds_read_b128 v[60:63], v9 offset:3072
  ds_read_b128 v[64:67], v9 offset:4096
  ds_read_b128 v[68:71], v9 offset:5120
  ds_read_b128 v[72:75], v9 offset:6144
  ds_read_b128 v[76:79], v9 offset:7168
  ds_read_b128 v[80:83], v9 offset:8192
  ds_read_b128 v[84:87], v9 offset:9216
  ds_read_b128 v[88:91], v9 offset:10240
  ds_read_b128 v[92:95], v9 offset:11264
  ds_read_b128 v[96:99], v9 offset:12288
  ds_read_b128 v[100:103], v9 offset:13312
  ds_read_b128 v[104:107], v9 offset:14336
  ds_read_b128 v[108:111], v9 offset:15360
  s_waitcnt vmcnt(0)
  v_lshlrev_b32 v24, 16, v16
  v_and_b32 v25, 0xffff0000, v16
  v_lshlrev_b32 v26, 16, v17
  v_and_b32 v27, 0xffff0000, v17
  v_lshlrev_b32 v28, 16, v18
  v_and_b32 v29, 0xffff0000, v18
  v_lshlrev_b32 v30, 16, v19
  v_and_b32 v31, 0xffff0000, v19
  v_lshlrev_b32 v32, 16, v20
  v_and_b32 v33, 0xffff0000, v20
  v_lshlrev_b32 v34, 16, v21
  v_and_b32 v35, 0xffff0000, v21
  v_lshlrev_b32 v36, 16, v22
  v_and_b32 v37, 0xffff0000, v22
  v_lshlrev_b32 v38, 16, v23
  v_and_b32 v39, 0xffff0000, v23
  s_waitcnt lgkmcnt(12)
  v_pk_add_f32 v[24:25], v[24:25], v[48:49]
  v_pk_add_f32 v[26:27], v[26:27], v[50:51]
  v_pk_add_f32 v[28:29], v[28:29], v[52:53]
  v_pk_add_f32 v[30:31], v[30:31], v[54:55]
  v_pk_add_f32 v[32:33], v[32:33], v[56:57]
  v_pk_add_f32 v[34:35], v[34:35], v[58:59]
  v_pk_add_f32 v[36:37], v[36:37], v[60:61]
  v_pk_add_f32 v[38:39], v[38:39], v[62:63]
  s_waitcnt lgkmcnt(8)
  v_pk_add_f32 v[24:25], v[24:25], v[64:65]
  v_pk_add_f32 v[26:27], v[26:27], v[66:67]
  v_pk_add_f32 v[28:29], v[28:29], v[68:69]
  v_pk_add_f32 v[30:31], v[30:31], v[70:71]
  v_pk_add_f32 v[32:33], v[32:33], v[72:73]
  v_pk_add_f32 v[34:35], v[34:35], v[74:75]
  v_pk_add_f32 v[36:37], v[36:37], v[76:77]
  v_pk_add_f32 v[38:39], v[38:39], v[78:79]
  s_waitcnt lgkmcnt(4)
  v_pk_add_f32 v[24:25], v[24:25], v[80:81]
  v_pk_add_f32 v[26:27], v[26:27], v[82:83]
  v_pk_add_f32 v[28:29], v[28:29], v[84:85]
  v_pk_add_f32 v[30:31], v[30:31], v[86:87]
  v_pk_add_f32 v[32:33], v[32:33], v[88:89]
  v_pk_add_f32 v[34:35], v[34:35], v[90:91]
  v_pk_add_f32 v[36:37], v[36:37], v[92:93]
  v_pk_add_f32 v[38:39], v[38:39], v[94:95]
  s_waitcnt lgkmcnt(0)
  v_pk_add_f32 v[24:25], v[24:25], v[96:97]
  v_pk_add_f32 v[26:27], v[26:27], v[98:99]
  v_pk_add_f32 v[28:29], v[28:29], v[100:101]
  v_pk_add_f32 v[30:31], v[30:31], v[102:103]
  v_pk_add_f32 v[32:33], v[32:33], v[104:105]
  v_pk_add_f32 v[34:35], v[34:35], v[106:107]
  v_pk_add_f32 v[36:37], v[36:37], v[108:109]
  v_pk_add_f32 v[38:39], v[38:39], v[110:111]
  v_cvt_pk_bf16_f32 v16, v24, v25
  v_cvt_pk_bf16_f32 v17, v26, v27
  v_cvt_pk_bf16_f32 v18, v28, v29
  v_cvt_pk_bf16_f32 v19, v30, v31
  v_cvt_pk_bf16_f32 v20, v32, v33
  v_cvt_pk_bf16_f32 v21, v34, v35
  v_cvt_pk_bf16_f32 v22, v36, v37
  v_cvt_pk_bf16_f32 v23, v38, v39
  s_lshl_b32 s48, s42, 14
  s_add_u32 s48, s48, s52
  s_lshl_b32 s49, s41, 7
  s_add_u32 s48, s48, s49
  v_lshlrev_b32 v9, 10, v2
  v_lshl_add_u32 v9, v3, 4, v9
  buffer_store_dwordx4 v[16:19], v9, s[28:31], s48 offen nt
  buffer_store_dwordx4 v[20:23], v9, s[28:31], s48 offen offset:64 nt
  s_endpgm
L_fsl_7:
  ds_read_b32 v13, v126
  s_waitcnt lgkmcnt(0)
  v_readfirstlane_b32 s84, v13
  s_nop 3
  s_cmp_le_u32 s84, 0
  s_cbranch_scc1 L_fsl_7
  s_branch L_fok_6
L_fsl_9:
  ds_read_b32 v13, v126
  s_waitcnt lgkmcnt(0)
  v_readfirstlane_b32 s84, v13
  s_nop 3
  s_cmp_le_u32 s84, 1
  s_cbranch_scc1 L_fsl_9
  s_branch L_fok_8
L_fsl_11:
  ds_read_b32 v13, v126
  s_waitcnt lgkmcnt(0)
  v_readfirstlane_b32 s84, v13
  s_nop 3
  s_cmp_le_u32 s84, 2
  s_cbranch_scc1 L_fsl_11
  s_branch L_fok_10
L_fsl_13:
  ds_read_b32 v13, v126
  s_waitcnt lgkmcnt(0)
  v_readfirstlane_b32 s84, v13
  s_nop 3
  s_cmp_le_u32 s84, 3
  s_cbranch_scc1 L_fsl_13
  s_branch L_fok_12
L_fsl_15:
  ds_read_b32 v13, v126
  s_waitcnt lgkmcnt(0)
  v_readfirstlane_b32 s84, v13
  s_nop 3
  s_cmp_le_u32 s84, 4
  s_cbranch_scc1 L_fsl_15
  s_branch L_fok_14
L_fsl_18:
  ds_read_b32 v13, v126
  s_waitcnt lgkmcnt(0)
  v_readfirstlane_b32 s84, v13
  s_nop 3
  s_cmp_le_u32 s84, 5
  s_cbranch_scc1 L_fsl_18
  s_branch L_fok_17
L_fsl_20:
  ds_read_b32 v13, v126
  s_waitcnt lgkmcnt(0)
  v_readfirstlane_b32 s84, v13
  s_nop 3
  s_cmp_le_u32 s84, 6
  s_cbranch_scc1 L_fsl_20
  s_branch L_fok_19
L_fsl_22:
  ds_read_b32 v13, v126
  s_waitcnt lgkmcnt(0)
  v_readfirstlane_b32 s84, v13
  s_nop 3
  s_cmp_le_u32 s84, 7
  s_cbranch_scc1 L_fsl_22
  s_branch L_fok_21
L_fsl_31:
  ds_read_b32 v13, v126
  s_waitcnt lgkmcnt(0)
  v_readfirstlane_b32 s84, v13
  s_nop 3
  s_cmp_le_u32 s84, 8
  s_cbranch_scc1 L_fsl_31
  s_branch L_fok_30
L_fsl_33:
  ds_read_b32 v13, v126
  s_waitcnt lgkmcnt(0)
  v_readfirstlane_b32 s84, v13
  s_nop 3
  s_cmp_le_u32 s84, 9
  s_cbranch_scc1 L_fsl_33
  s_branch L_fok_32
L_fsl_35:
  ds_read_b32 v13, v126
  s_waitcnt lgkmcnt(0)
  v_readfirstlane_b32 s84, v13
  s_nop 3
  s_cmp_le_u32 s84, 10
  s_cbranch_scc1 L_fsl_35
  s_branch L_fok_34
L_fsl_37:
  ds_read_b32 v13, v126
  s_waitcnt lgkmcnt(0)
  v_readfirstlane_b32 s84, v13
  s_nop 3
  s_cmp_le_u32 s84, 11
  s_cbranch_scc1 L_fsl_37
  s_branch L_fok_36
L_fsl_39:
  ds_read_b32 v13, v126
  s_waitcnt lgkmcnt(0)
  v_readfirstlane_b32 s84, v13
  s_nop 3
  s_cmp_le_u32 s84, 12
  s_cbranch_scc1 L_fsl_39
  s_branch L_fok_38
L_fsl_42:
  ds_read_b32 v13, v126
  s_waitcnt lgkmcnt(0)
  v_readfirstlane_b32 s84, v13
  s_nop 3
  s_cmp_le_u32 s84, 13
  s_cbranch_scc1 L_fsl_42
  s_branch L_fok_41
L_fsl_44:
  ds_read_b32 v13, v126
  s_waitcnt lgkmcnt(0)
  v_readfirstlane_b32 s84, v13
  s_nop 3
  s_cmp_le_u32 s84, 14
  s_cbranch_scc1 L_fsl_44
  s_branch L_fok_43
L_fsl_46:
  ds_read_b32 v13, v126
  s_waitcnt lgkmcnt(0)
  v_readfirstlane_b32 s84, v13
  s_nop 3
  s_cmp_le_u32 s84, 15
  s_cbranch_scc1 L_fsl_46
  s_branch L_fok_45
L_fsl_49:
  ds_read_b32 v13, v126
  s_waitcnt lgkmcnt(0)
  v_readfirstlane_b32 s84, v13
  s_nop 3
  s_cmp_le_u32 s84, 16
  s_cbranch_scc1 L_fsl_49
  s_branch L_fok_48
L_fsl_51:
  ds_read_b32 v13, v126
  s_waitcnt lgkmcnt(0)
  v_readfirstlane_b32 s84, v13
  s_nop 3
  s_cmp_le_u32 s84, 17
  s_cbranch_scc1 L_fsl_51
  s_branch L_fok_50
L_fsl_53:
  ds_read_b32 v13, v126
  s_waitcnt lgkmcnt(0)
  v_readfirstlane_b32 s84, v13
  s_nop 3
  s_cmp_le_u32 s84, 18
  s_cbranch_scc1 L_fsl_53
  s_branch L_fok_52
L_fsl_55:
  ds_read_b32 v13, v126
  s_waitcnt lgkmcnt(0)
  v_readfirstlane_b32 s84, v13
  s_nop 3
  s_cmp_le_u32 s84, 19
  s_cbranch_scc1 L_fsl_55
  s_branch L_fok_54
L_fsl_57:
  ds_read_b32 v13, v126
  s_waitcnt lgkmcnt(0)
  v_readfirstlane_b32 s84, v13
  s_nop 3
  s_cmp_le_u32 s84, 20
  s_cbranch_scc1 L_fsl_57
  s_branch L_fok_56
L_fsl_59:
  ds_read_b32 v13, v126
  s_waitcnt lgkmcnt(0)
  v_readfirstlane_b32 s84, v13
  s_nop 3
  s_cmp_le_u32 s84, 21
  s_cbranch_scc1 L_fsl_59
  s_branch L_fok_58
L_fsl_61:
  ds_read_b32 v13, v126
  s_waitcnt lgkmcnt(0)
  v_readfirstlane_b32 s84, v13
  s_nop 3
  s_cmp_le_u32 s84, 22
  s_cbranch_scc1 L_fsl_61
  s_branch L_fok_60
L_fsl_63:
  ds_read_b32 v13, v126
  s_waitcnt lgkmcnt(0)
  v_readfirstlane_b32 s84, v13
  s_nop 3
  s_cmp_le_u32 s84, 23
  s_cbranch_scc1 L_fsl_63
  s_branch L_fok_62
L_fsl_65:
  ds_read_b32 v13, v126
  s_waitcnt lgkmcnt(0)
  v_readfirstlane_b32 s84, v13
  s_nop 3
  s_cmp_le_u32 s84, 24
  s_cbranch_scc1 L_fsl_65
  s_branch L_fok_64
L_fsl_67:
  ds_read_b32 v13, v126
  s_waitcnt lgkmcnt(0)
  v_readfirstlane_b32 s84, v13
  s_nop 3
  s_cmp_le_u32 s84, 25
  s_cbranch_scc1 L_fsl_67
  s_branch L_fok_66
L_fsl_69:
  ds_read_b32 v13, v126
  s_waitcnt lgkmcnt(0)
  v_readfirstlane_b32 s84, v13
  s_nop 3
  s_cmp_le_u32 s84, 26
  s_cbranch_scc1 L_fsl_69
  s_branch L_fok_68
L_fsl_71:
  ds_read_b32 v13, v126
  s_waitcnt lgkmcnt(0)
  v_readfirstlane_b32 s84, v13
  s_nop 3
  s_cmp_le_u32 s84, 27
  s_cbranch_scc1 L_fsl_71
  s_branch L_fok_70
L_fsl_73:
  ds_read_b32 v13, v126
  s_waitcnt lgkmcnt(0)
  v_readfirstlane_b32 s84, v13
  s_nop 3
  s_cmp_le_u32 s84, 28
  s_cbranch_scc1 L_fsl_73
  s_branch L_fok_72
L_fsl_75:
  ds_read_b32 v13, v126
  s_waitcnt lgkmcnt(0)
  v_readfirstlane_b32 s84, v13
  s_nop 3
  s_cmp_le_u32 s84, 29
  s_cbranch_scc1 L_fsl_75
  s_branch L_fok_74
L_fsl_77:
  ds_read_b32 v13, v126
  s_waitcnt lgkmcnt(0)
  v_readfirstlane_b32 s84, v13
  s_nop 3
  s_cmp_le_u32 s84, 30
  s_cbranch_scc1 L_fsl_77
  s_branch L_fok_76
L_fsl_83:
  ds_read_b32 v13, v126
  s_waitcnt lgkmcnt(0)
  v_readfirstlane_b32 s84, v13
  s_nop 3
  s_cmp_le_u32 s84, 31
  s_cbranch_scc1 L_fsl_83
  s_branch L_fok_82
L_fsl_86:
  ds_read_b32 v13, v126
  s_waitcnt lgkmcnt(0)
  v_readfirstlane_b32 s84, v13
  s_nop 3
  s_cmp_le_u32 s84, 32
  s_cbranch_scc1 L_fsl_86
  s_branch L_fok_85
L_fsl_88:
  ds_read_b32 v13, v126
  s_waitcnt lgkmcnt(0)
  v_readfirstlane_b32 s84, v13
  s_nop 3
  s_cmp_le_u32 s84, 33
  s_cbranch_scc1 L_fsl_88
  s_branch L_fok_87
L_fsl_90:
  ds_read_b32 v13, v126
  s_waitcnt lgkmcnt(0)
  v_readfirstlane_b32 s84, v13
  s_nop 3
  s_cmp_le_u32 s84, 34
  s_cbranch_scc1 L_fsl_90
  s_branch L_fok_89
L_fsl_92:
  ds_read_b32 v13, v126
  s_waitcnt lgkmcnt(0)
  v_readfirstlane_b32 s84, v13
  s_nop 3
  s_cmp_le_u32 s84, 35
  s_cbranch_scc1 L_fsl_92
  s_branch L_fok_91
L_fsl_94:
  ds_read_b32 v13, v126
  s_waitcnt lgkmcnt(0)
  v_readfirstlane_b32 s84, v13
  s_nop 3
  s_cmp_le_u32 s84, 36
  s_cbranch_scc1 L_fsl_94
  s_branch L_fok_93
L_fsl_96:
  ds_read_b32 v13, v126
  s_waitcnt lgkmcnt(0)
  v_readfirstlane_b32 s84, v13
  s_nop 3
  s_cmp_le_u32 s84, 37
  s_cbranch_scc1 L_fsl_96
  s_branch L_fok_95
L_loader:
  s_lshl_b32 s7, s41, 2
  s_add_u32 s7, s7, s42
  s_lshl_b32 s7, s7, 13
  v_lshlrev_b32 v9, 7, v1
  v_add_u32 v9, s7, v9
  s_cmp_ge_u32 s40, 8
  s_cbranch_scc1 L_nocpf
  s_cmp_ge_u32 s7, L_end-L_pc
  s_cbranch_scc1 L_nocpf
  v_min_u32 v9, L_end-L_pc, v9
  global_load_dword v60, v9, s[4:5]
L_nocpf:
  v_lshrrev_b32 v9, 3, v1
  v_and_b32 v10, 7, v1
  v_xor_b32 v11, v9, v10
  v_lshlrev_b32 v11, 4, v11
  v_lshl_add_u32 v16, v9, 10, v11
  s_sub_u32 s7, s52, 16384
  s_mov_b32 s80, 0xffffff00
  s_mov_b32 s81, -1
  v_and_b32 v11, 1, v3
  s_and_b32 s48, s42, 1
  s_lshl_b32 s48, s48, 2
  v_lshlrev_b32 v11, 1, v11
  v_or_b32 v11, s48, v11
  v_xor_b32 v11, v11, v10
  v_lshlrev_b32 v11, 4, v11
  s_lshl_b32 s48, s42, 3
  v_add_u32 v12, s48, v9
  s_movk_i32 s49, 3072
  v_mul_lo_u32 v12, v12, s49
  s_lshl_b32 s48, s41, 7
  v_add3_u32 v19, v12, v11, s48
  s_mul_i32 s48, s42, 3072
  s_add_u32 s46, s48, 81920
  s_add_u32 s78, s46, 73728
  s_lshr_b32 s74, s40, 3
  s_lshl_b32 s74, s74, 1
  s_add_u32 s74, s74, s41
  s_add_u32 s74, s74, s40
  s_and_b32 s74, s74, 7
  s_mul_i32 s47, s74, 196608
  s_movk_i32 s50, 128
  s_mul_i32 s51, s42, 20480
  s_waitcnt lgkmcnt(0)
  s_mov_b32 s12, s86
  s_and_b32 s13, s87, 0xffff
  s_mov_b32 s14, 1572864
  s_mov_b32 s15, 0x20000
  s_mov_b32 s8, s84
  s_and_b32 s9, s85, 0xffff
  s_mov_b32 s10, 2097152
  s_mov_b32 s11, 0x20000
  s_mov_b32 s36, s100
  s_and_b32 s37, s101, 0xffff
  s_mov_b32 s38, 268435456
  s_mov_b32 s39, 0x20000
  v_lshrrev_b32 v24, 2, v1
  v_lshlrev_b32 v24, 7, v24
  v_and_b32 v9, 3, v1
  v_lshl_add_u32 v24, v9, 4, v24
  s_lshr_b32 s76, s40, 3
  s_lshl_b32 s76, s76, 3
  s_add_u32 s76, s76, s41
  s_lshl_b32 s76, s76, 2
  s_add_u32 s76, s76, s42
  s_or_b32 s77, s41, s42
  s_cmp_lg_u32 s77, 0
  s_cbranch_scc1 L_nozero
  v_mov_b32 v22, 0
  v_mov_b32 v23, 0
  v_lshlrev_b32 v11, 3, v1
  s_lshl_b32 s48, s40, 9
  buffer_store_dwordx2 v[22:23], v11, s[36:39], s48 offen sc1
L_nozero:
  s_cmp_lg_u32 s42, 1
  s_cbranch_scc1 L_noones
  v_mov_b32 v28, 0x3f803f80
  v_mov_b32 v29, 0x3f803f80
  v_mov_b32 v30, 0x3f803f80
  v_mov_b32 v31, 0x3f803f80
  v_lshrrev_b32 v9, 3, v1
  s_movk_i32 s49, 10240
  v_mul_lo_u32 v9, v9, s49
  v_and_b32 v10, 7, v1
  v_lshl_add_u32 v9, v10, 4, v9
  ds_write_b128 v9, v[28:31] offset:0
L_noones:
  s_add_u32 m0, s46, 0
  s_nop 0
  buffer_load_dwordx4 v19, s[12:15], s47 offen offset:0 lds
  buffer_load_dwordx4 v19, s[12:15], s47 offen offset:1024 lds
  buffer_load_dwordx4 v19, s[12:15], s47 offen offset:2048 lds
  s_add_u32 s47, s47, 98304
  s_add_u32 m0, s46, 12288
  s_nop 0
  buffer_load_dwordx4 v19, s[12:15], s47 offen offset:0 lds
  buffer_load_dwordx4 v19, s[12:15], s47 offen offset:1024 lds
  buffer_load_dwordx4 v19, s[12:15], s47 offen offset:2048 lds
  s_add_u32 s47, s47, 98304
  s_add_u32 s46, s46, 24576
  s_cmp_eq_u32 s46, s78
  s_cselect_b32 s49, 73728, 0
  s_sub_u32 s46, s46, s49
  s_cmp_eq_u32 s47, 1572864
  s_cselect_b32 s47, 0, s47
  s_add_u32 s48, s42, 0
  s_cmp_ge_u32 s48, 10
  s_cselect_b32 s49, 10, 0
  s_cselect_b32 s50, 1, 0
  s_sub_u32 s49, s48, s49
  s_cmp_eq_u32 s49, 0
  s_cselect_b64 exec, s[80:81], -1
  s_lshl_b32 s48, s48, 10
  s_add_u32 m0, s48, 0
  s_lshl_b32 s49, s49, 13
  s_add_u32 s50, s50, s74
  s_and_b32 s50, s50, 7
  s_lshl_b32 s50, s50, 7
  s_add_u32 s49, s49, s50
  s_add_u32 s49, s49, s7
  buffer_load_dwordx4 v16, s[8:11], s49 offen lds
  s_mov_b64 exec, -1
  s_add_u32 s48, s42, 4
  s_cmp_ge_u32 s48, 10
  s_cselect_b32 s49, 10, 0
  s_cselect_b32 s50, 1, 0
  s_sub_u32 s49, s48, s49
  s_lshl_b32 s48, s48, 10
  s_add_u32 m0, s48, 0
  s_lshl_b32 s49, s49, 13
  s_add_u32 s50, s50, s74
  s_and_b32 s50, s50, 7
  s_lshl_b32 s50, s50, 7
  s_add_u32 s49, s49, s50
  s_add_u32 s49, s49, s7
  buffer_load_dwordx4 v16, s[8:11], s49 offen lds
  s_add_u32 s48, s42, 8
  s_cmp_ge_u32 s48, 10
  s_cselect_b32 s49, 10, 0
  s_cselect_b32 s50, 1, 0
  s_sub_u32 s49, s48, s49
  s_cmp_eq_u32 s49, 0
  s_cselect_b64 exec, s[80:81], -1
  s_lshl_b32 s48, s48, 10
  s_add_u32 m0, s48, 0
  s_lshl_b32 s49, s49, 13
  s_add_u32 s50, s50, s74
  s_and_b32 s50, s50, 7
  s_lshl_b32 s50, s50, 7
  s_add_u32 s49, s49, s50
  s_add_u32 s49, s49, s7
  buffer_load_dwordx4 v16, s[8:11], s49 offen lds
  s_mov_b64 exec, -1
  s_add_u32 s48, s42, 12
  s_cmp_ge_u32 s48, 10
  s_cselect_b32 s49, 10, 0
  s_cselect_b32 s50, 1, 0
  s_sub_u32 s49, s48, s49
  s_lshl_b32 s48, s48, 10
  s_add_u32 m0, s48, 0
  s_lshl_b32 s49, s49, 13
  s_add_u32 s50, s50, s74
  s_and_b32 s50, s50, 7
  s_lshl_b32 s50, s50, 7
  s_add_u32 s49, s49, s50
  s_add_u32 s49, s49, s7
  buffer_load_dwordx4 v16, s[8:11], s49 offen lds
  s_add_u32 s48, s42, 16
  s_cmp_ge_u32 s48, 10
  s_cselect_b32 s49, 10, 0
  s_cselect_b32 s50, 1, 0
  s_sub_u32 s49, s48, s49
  s_lshl_b32 s48, s48, 10
  s_add_u32 m0, s48, 0
  s_lshl_b32 s49, s49, 13
  s_add_u32 s50, s50, s74
  s_and_b32 s50, s50, 7
  s_lshl_b32 s50, s50, 7
  s_add_u32 s49, s49, s50
  s_add_u32 s49, s49, s7
  buffer_load_dwordx4 v16, s[8:11], s49 offen lds
  s_add_u32 m0, s46, 0
  s_nop 0
  buffer_load_dwordx4 v19, s[12:15], s47 offen offset:0 lds
  buffer_load_dwordx4 v19, s[12:15], s47 offen offset:1024 lds
  buffer_load_dwordx4 v19, s[12:15], s47 offen offset:2048 lds
  s_add_u32 s47, s47, 98304
  s_add_u32 m0, s46, 12288
  s_nop 0
  buffer_load_dwordx4 v19, s[12:15], s47 offen offset:0 lds
  buffer_load_dwordx4 v19, s[12:15], s47 offen offset:1024 lds
  buffer_load_dwordx4 v19, s[12:15], s47 offen offset:2048 lds
  s_add_u32 s47, s47, 98304
  s_add_u32 s46, s46, 24576
  s_cmp_eq_u32 s46, s78
  s_cselect_b32 s49, 73728, 0
  s_sub_u32 s46, s46, s49
  s_cmp_eq_u32 s47, 1572864
  s_cselect_b32 s47, 0, s47
  s_mov_b32 s32, s98
  s_and_b32 s33, s99, 0xffff
  s_mov_b32 s34, 256
  s_mov_b32 s35, 0x20000
  s_mov_b32 s16, s88
  s_and_b32 s17, s89, 0xffff
  s_mov_b32 s18, 524288
  s_mov_b32 s19, 0x20000
  s_mov_b32 s20, s92
  s_and_b32 s21, s93, 0xffff
  s_mov_b32 s22, 1835008
  s_mov_b32 s23, 0x20000
  s_mov_b32 s24, s94
  s_and_b32 s25, s95, 0xffff
  s_mov_b32 s26, 1835008
  s_mov_b32 s27, 0x20000
  s_mov_b32 s101, 0
  s_cmp_lg_u32 s42, 1
  s_cbranch_scc1 L_noctl
  v_mov_b32 v22, 0
  v_lshlrev_b32 v9, 2, v1
  v_add_u32 v9, 162816, v9
  s_mov_b64 exec, 0xffff
  ds_write_b32 v9, v22
  s_mov_b64 exec, -1
L_noctl:
  s_getreg_b32 s48, hwreg(HW_REG_XCC_ID, 0, 4)
  s_add_u32 s43, s48, 1
  s_waitcnt vmcnt(6)
  s_waitcnt lgkmcnt(0)
  s_barrier
  s_add_u32 s48, s42, 0
  s_cmp_ge_u32 s48, 10
  s_cselect_b32 s49, 10, 0
  s_cselect_b32 s50, 3, 2
  s_sub_u32 s49, s48, s49
  s_cmp_eq_u32 s49, 0
  s_cselect_b64 exec, s[80:81], -1
  s_lshl_b32 s48, s48, 10
  s_add_u32 m0, s48, 20480
  s_lshl_b32 s49, s49, 13
  s_add_u32 s50, s50, s74
  s_and_b32 s50, s50, 7
  s_lshl_b32 s50, s50, 7
  s_add_u32 s49, s49, s50
  s_add_u32 s49, s49, s7
  buffer_load_dwordx4 v16, s[8:11], s49 offen lds
  s_mov_b64 exec, -1
  s_add_u32 s48, s42, 4
  s_cmp_ge_u32 s48, 10
  s_cselect_b32 s49, 10, 0
  s_cselect_b32 s50, 3, 2
  s_sub_u32 s49, s48, s49
  s_lshl_b32 s48, s48, 10
  s_add_u32 m0, s48, 20480
  s_lshl_b32 s49, s49, 13
  s_add_u32 s50, s50, s74
  s_and_b32 s50, s50, 7
  s_lshl_b32 s50, s50, 7
  s_add_u32 s49, s49, s50
  s_add_u32 s49, s49, s7
  buffer_load_dwordx4 v16, s[8:11], s49 offen lds
  s_add_u32 s48, s42, 8
  s_cmp_ge_u32 s48, 10
  s_cselect_b32 s49, 10, 0
  s_cselect_b32 s50, 3, 2
  s_sub_u32 s49, s48, s49
  s_cmp_eq_u32 s49, 0
  s_cselect_b64 exec, s[80:81], -1
  s_lshl_b32 s48, s48, 10
  s_add_u32 m0, s48, 20480
  s_lshl_b32 s49, s49, 13
  s_add_u32 s50, s50, s74
  s_and_b32 s50, s50, 7
  s_lshl_b32 s50, s50, 7
  s_add_u32 s49, s49, s50
  s_add_u32 s49, s49, s7
  buffer_load_dwordx4 v16, s[8:11], s49 offen lds
  s_mov_b64 exec, -1
  s_add_u32 s48, s42, 12
  s_cmp_ge_u32 s48, 10
  s_cselect_b32 s49, 10, 0
  s_cselect_b32 s50, 3, 2
  s_sub_u32 s49, s48, s49
  s_lshl_b32 s48, s48, 10
  s_add_u32 m0, s48, 20480
  s_lshl_b32 s49, s49, 13
  s_add_u32 s50, s50, s74
  s_and_b32 s50, s50, 7
  s_lshl_b32 s50, s50, 7
  s_add_u32 s49, s49, s50
  s_add_u32 s49, s49, s7
  buffer_load_dwordx4 v16, s[8:11], s49 offen lds
  s_add_u32 s48, s42, 16
  s_cmp_ge_u32 s48, 10
  s_cselect_b32 s49, 10, 0
  s_cselect_b32 s50, 3, 2
  s_sub_u32 s49, s48, s49
  s_lshl_b32 s48, s48, 10
  s_add_u32 m0, s48, 20480
  s_lshl_b32 s49, s49, 13
  s_add_u32 s50, s50, s74
  s_and_b32 s50, s50, 7
  s_lshl_b32 s50, s50, 7
  s_add_u32 s49, s49, s50
  s_add_u32 s49, s49, s7
  buffer_load_dwordx4 v16, s[8:11], s49 offen lds
  s_add_u32 m0, s46, 0
  s_nop 0
  buffer_load_dwordx4 v19, s[12:15], s47 offen offset:0 lds
  buffer_load_dwordx4 v19, s[12:15], s47 offen offset:1024 lds
  buffer_load_dwordx4 v19, s[12:15], s47 offen offset:2048 lds
  s_add_u32 s47, s47, 98304
  s_add_u32 m0, s46, 12288
  s_nop 0
  buffer_load_dwordx4 v19, s[12:15], s47 offen offset:0 lds
  buffer_load_dwordx4 v19, s[12:15], s47 offen offset:1024 lds
  buffer_load_dwordx4 v19, s[12:15], s47 offen offset:2048 lds
  s_add_u32 s47, s47, 98304
  s_add_u32 s46, s46, 24576
  s_cmp_eq_u32 s46, s78
  s_cselect_b32 s49, 73728, 0
  s_sub_u32 s46, s46, s49
  s_cmp_eq_u32 s47, 1572864
  s_cselect_b32 s47, 0, s47
  s_add_u32 s48, s42, 0
  s_cmp_ge_u32 s48, 10
  s_cselect_b32 s49, 10, 0
  s_cselect_b32 s50, 5, 4
  s_sub_u32 s49, s48, s49
  s_cmp_eq_u32 s49, 0
  s_cselect_b64 exec, s[80:81], -1
  s_lshl_b32 s48, s48, 10
  s_add_u32 m0, s48, 40960
  s_lshl_b32 s49, s49, 13
  s_add_u32 s50, s50, s74
  s_and_b32 s50, s50, 7
  s_lshl_b32 s50, s50, 7
  s_add_u32 s49, s49, s50
  s_add_u32 s49, s49, s7
  buffer_load_dwordx4 v16, s[8:11], s49 offen lds
  s_mov_b64 exec, -1
  s_add_u32 s48, s42, 4
  s_cmp_ge_u32 s48, 10
  s_cselect_b32 s49, 10, 0
  s_cselect_b32 s50, 5, 4
  s_sub_u32 s49, s48, s49
  s_lshl_b32 s48, s48, 10
  s_add_u32 m0, s48, 40960
  s_lshl_b32 s49, s49, 13
  s_add_u32 s50, s50, s74
  s_and_b32 s50, s50, 7
  s_lshl_b32 s50, s50, 7
  s_add_u32 s49, s49, s50
  s_add_u32 s49, s49, s7
  buffer_load_dwordx4 v16, s[8:11], s49 offen lds
  s_add_u32 s48, s42, 8
  s_cmp_ge_u32 s48, 10
  s_cselect_b32 s49, 10, 0
  s_cselect_b32 s50, 5, 4
  s_sub_u32 s49, s48, s49
  s_cmp_eq_u32 s49, 0
  s_cselect_b64 exec, s[80:81], -1
  s_lshl_b32 s48, s48, 10
  s_add_u32 m0, s48, 40960
  s_lshl_b32 s49, s49, 13
  s_add_u32 s50, s50, s74
  s_and_b32 s50, s50, 7
  s_lshl_b32 s50, s50, 7
  s_add_u32 s49, s49, s50
  s_add_u32 s49, s49, s7
  buffer_load_dwordx4 v16, s[8:11], s49 offen lds
  s_mov_b64 exec, -1
  s_add_u32 s48, s42, 12
  s_cmp_ge_u32 s48, 10
  s_cselect_b32 s49, 10, 0
  s_cselect_b32 s50, 5, 4
  s_sub_u32 s49, s48, s49
  s_lshl_b32 s48, s48, 10
  s_add_u32 m0, s48, 40960
  s_lshl_b32 s49, s49, 13
  s_add_u32 s50, s50, s74
  s_and_b32 s50, s50, 7
  s_lshl_b32 s50, s50, 7
  s_add_u32 s49, s49, s50
  s_add_u32 s49, s49, s7
  buffer_load_dwordx4 v16, s[8:11], s49 offen lds
  s_add_u32 s48, s42, 16
  s_cmp_ge_u32 s48, 10
  s_cselect_b32 s49, 10, 0
  s_cselect_b32 s50, 5, 4
  s_sub_u32 s49, s48, s49
  s_lshl_b32 s48, s48, 10
  s_add_u32 m0, s48, 40960
  s_lshl_b32 s49, s49, 13
  s_add_u32 s50, s50, s74
  s_and_b32 s50, s50, 7
  s_lshl_b32 s50, s50, 7
  s_add_u32 s49, s49, s50
  s_add_u32 s49, s49, s7
  buffer_load_dwordx4 v16, s[8:11], s49 offen lds
  s_add_u32 s48, s42, 0
  s_cmp_ge_u32 s48, 10
  s_cselect_b32 s49, 10, 0
  s_cselect_b32 s50, 7, 6
  s_sub_u32 s49, s48, s49
  s_cmp_eq_u32 s49, 0
  s_cselect_b64 exec, s[80:81], -1
  s_lshl_b32 s48, s48, 10
  s_add_u32 m0, s48, 61440
  s_lshl_b32 s49, s49, 13
  s_add_u32 s50, s50, s74
  s_and_b32 s50, s50, 7
  s_lshl_b32 s50, s50, 7
  s_add_u32 s49, s49, s50
  s_add_u32 s49, s49, s7
  buffer_load_dwordx4 v16, s[8:11], s49 offen lds
  s_mov_b64 exec, -1
  s_add_u32 s48, s42, 4
  s_cmp_ge_u32 s48, 10
  s_cselect_b32 s49, 10, 0
  s_cselect_b32 s50, 7, 6
  s_sub_u32 s49, s48, s49
  s_lshl_b32 s48, s48, 10
  s_add_u32 m0, s48, 61440
  s_lshl_b32 s49, s49, 13
  s_add_u32 s50, s50, s74
  s_and_b32 s50, s50, 7
  s_lshl_b32 s50, s50, 7
  s_add_u32 s49, s49, s50
  s_add_u32 s49, s49, s7
  buffer_load_dwordx4 v16, s[8:11], s49 offen lds
  s_add_u32 s48, s42, 8
  s_cmp_ge_u32 s48, 10
  s_cselect_b32 s49, 10, 0
  s_cselect_b32 s50, 7, 6
  s_sub_u32 s49, s48, s49
  s_cmp_eq_u32 s49, 0
  s_cselect_b64 exec, s[80:81], -1
  s_lshl_b32 s48, s48, 10
  s_add_u32 m0, s48, 61440
  s_lshl_b32 s49, s49, 13
  s_add_u32 s50, s50, s74
  s_and_b32 s50, s50, 7
  s_lshl_b32 s50, s50, 7
  s_add_u32 s49, s49, s50
  s_add_u32 s49, s49, s7
  buffer_load_dwordx4 v16, s[8:11], s49 offen lds
  s_mov_b64 exec, -1
  s_add_u32 s48, s42, 12
  s_cmp_ge_u32 s48, 10
  s_cselect_b32 s49, 10, 0
  s_cselect_b32 s50, 7, 6
  s_sub_u32 s49, s48, s49
  s_lshl_b32 s48, s48, 10
  s_add_u32 m0, s48, 61440
  s_lshl_b32 s49, s49, 13
  s_add_u32 s50, s50, s74
  s_and_b32 s50, s50, 7
  s_lshl_b32 s50, s50, 7
  s_add_u32 s49, s49, s50
  s_add_u32 s49, s49, s7
  buffer_load_dwordx4 v16, s[8:11], s49 offen lds
  s_add_u32 s48, s42, 16
  s_cmp_ge_u32 s48, 10
  s_cselect_b32 s49, 10, 0
  s_cselect_b32 s50, 7, 6
  s_sub_u32 s49, s48, s49
  s_lshl_b32 s48, s48, 10
  s_add_u32 m0, s48, 61440
  s_lshl_b32 s49, s49, 13
  s_add_u32 s50, s50, s74
  s_and_b32 s50, s50, 7
  s_lshl_b32 s50, s50, 7
  s_add_u32 s49, s49, s50
  s_add_u32 s49, s49, s7
  buffer_load_dwordx4 v16, s[8:11], s49 offen lds
  s_cmp_lg_u32 s77, 0
  s_cbranch_scc1 L_noready
  s_lshl_b32 s48, s40, 3
  v_mov_b32 v22, 1
  v_mov_b32 v10, s48
  s_mov_b64 exec, 1
  buffer_store_dword v22, v10, s[32:35], 0 offen sc1
  s_mov_b64 exec, -1
L_noready:
  s_lshl_b32 s48, s42, 2
  s_add_u32 s48, s48, 162816
  v_mov_b32 v25, s48
  s_lshl_b32 s48, s42, 12
  v_add_u32 v26, s48, v4
  v_lshrrev_b32 v11, 2, v1
  v_lshlrev_b32 v11, 10, v11
  v_and_b32 v10, 3, v1
  v_lshl_add_u32 v11, v10, 4, v11
  s_and_b32 s48, s41, 3
  s_lshl_b32 s48, s48, 8
  s_lshl_b32 s49, s42, 6
  s_add_u32 s48, s48, s49
  v_add_u32 v20, s48, v11
  v_and_b32 v11, 1, v3
  v_lshlrev_b32 v11, 2, v11
  v_and_b32 v10, 7, v1
  v_xor_b32 v11, v11, v10
  v_lshlrev_b32 v11, 4, v11
  v_lshrrev_b32 v10, 3, v1
  s_movk_i32 s48, 3584
  v_mul_lo_u32 v21, v10, s48
  s_lshl_b32 s48, s41, 9
  s_lshl_b32 s49, s42, 7
  s_add_u32 s48, s48, s49
  v_add3_u32 v21, v21, v11, s48
  v_lshl_add_u32 v14, v10, 10, v11
  s_lshl_b32 s48, s41, 7
  v_add_u32 v14, s48, v14
  s_lshr_b32 s51, s40, 3
  s_lshl_b32 s48, s51, 1
  s_lshr_b32 s49, s41, 2
  s_add_u32 s48, s48, s49
  s_and_b32 s48, s48, 7
  s_lshl_b32 s86, s48, 16
  s_lshl_b32 s48, s51, 2
  s_and_b32 s49, s40, 3
  s_add_u32 s48, s48, s49
  s_mul_i32 s87, s48, 114688
  s_mul_i32 s88, s42, 458752
  s_add_u32 s89, s88, 458752
  s_mul_i32 s48, s51, 7
  s_lshr_b32 s48, s48, 1
  s_and_b32 s49, s40, 3
  s_add_u32 s48, s48, s49
  s_mul_i32 s48, s48, 32768
  s_add_u32 s88, s88, s48
  s_cmp_eq_u32 s41, 7
  s_cselect_b32 s22, 0, s22
  s_mov_b32 s90, 0
  v_add_u32 v27, 65536, v26
  s_waitcnt vmcnt(21)
  s_barrier
  s_add_u32 m0, s46, 0
  s_nop 0
  buffer_load_dwordx4 v19, s[12:15], s47 offen offset:0 lds
  buffer_load_dwordx4 v19, s[12:15], s47 offen offset:1024 lds
  buffer_load_dwordx4 v19, s[12:15], s47 offen offset:2048 lds
  s_add_u32 s47, s47, 98304
  s_add_u32 m0, s46, 12288
  s_nop 0
  buffer_load_dwordx4 v19, s[12:15], s47 offen offset:0 lds
  buffer_load_dwordx4 v19, s[12:15], s47 offen offset:1024 lds
  buffer_load_dwordx4 v19, s[12:15], s47 offen offset:2048 lds
  s_add_u32 s47, s47, 98304
  s_add_u32 s46, s46, 24576
  s_cmp_eq_u32 s46, s78
  s_cselect_b32 s49, 73728, 0
  s_sub_u32 s46, s46, s49
  s_cmp_eq_u32 s47, 1572864
  s_cselect_b32 s47, 0, s47
  s_waitcnt vmcnt(16)
  s_barrier
  s_add_u32 m0, s46, 0
  s_nop 0
  buffer_load_dwordx4 v19, s[12:15], s47 offen offset:0 lds
  buffer_load_dwordx4 v19, s[12:15], s47 offen offset:1024 lds
  buffer_load_dwordx4 v19, s[12:15], s47 offen offset:2048 lds
  s_add_u32 s47, s47, 98304
  s_add_u32 m0, s46, 12288
  s_nop 0
  buffer_load_dwordx4 v19, s[12:15], s47 offen offset:0 lds
  buffer_load_dwordx4 v19, s[12:15], s47 offen offset:1024 lds
  buffer_load_dwordx4 v19, s[12:15], s47 offen offset:2048 lds
  s_add_u32 s47, s47, 98304
  s_add_u32 s46, s46, 24576
  s_cmp_eq_u32 s46, s78
  s_cselect_b32 s49, 73728, 0
  s_sub_u32 s46, s46, s49
  s_cmp_eq_u32 s47, 1572864
  s_cselect_b32 s47, 0, s47
  s_waitcnt vmcnt(6)
  s_barrier
  s_add_u32 m0, s46, 0
  s_nop 0
  buffer_load_dwordx4 v19, s[12:15], s47 offen offset:0 lds
  buffer_load_dwordx4 v19, s[12:15], s47 offen offset:1024 lds
  buffer_load_dwordx4 v19, s[12:15], s47 offen offset:2048 lds
  s_add_u32 s47, s47, 98304
  s_add_u32 m0, s46, 12288
  s_nop 0
  buffer_load_dwordx4 v19, s[12:15], s47 offen offset:0 lds
  buffer_load_dwordx4 v19, s[12:15], s47 offen offset:1024 lds
  buffer_load_dwordx4 v19, s[12:15], s47 offen offset:2048 lds
  s_add_u32 s47, s47, 98304
  s_add_u32 s46, s46, 24576
  s_cmp_eq_u32 s46, s78
  s_cselect_b32 s49, 73728, 0
  s_sub_u32 s46, s46, s49
  s_cmp_eq_u32 s47, 1572864
  s_cselect_b32 s47, 0, s47
  s_waitcnt vmcnt(6)
  s_barrier
  s_add_u32 m0, s46, 0
  s_nop 0
  buffer_load_dwordx4 v19, s[12:15], s47 offen offset:0 lds
  buffer_load_dwordx4 v19, s[12:15], s47 offen offset:1024 lds
  buffer_load_dwordx4 v19, s[12:15], s47 offen offset:2048 lds
  s_add_u32 s47, s47, 98304
  s_add_u32 m0, s46, 12288
  s_nop 0
  buffer_load_dwordx4 v19, s[12:15], s47 offen offset:0 lds
  buffer_load_dwordx4 v19, s[12:15], s47 offen offset:1024 lds
  buffer_load_dwordx4 v19, s[12:15], s47 offen offset:2048 lds
  s_add_u32 s47, s47, 98304
  s_add_u32 s46, s46, 24576
  s_cmp_eq_u32 s46, s78
  s_cselect_b32 s49, 73728, 0
  s_sub_u32 s46, s46, s49
  s_cmp_eq_u32 s47, 1572864
  s_cselect_b32 s47, 0, s47
  s_cmp_lg_u32 s42, 0
  s_cbranch_scc1 L_n0_97
  s_lshl_b32 s48, s40, 3
  v_mov_b32 v10, s48
  buffer_load_dword v22, v10, s[32:35], 0 offen sc1
L_n0_97:
  s_waitcnt vmcnt(6)
  s_barrier
  s_add_u32 m0, s46, 0
  s_nop 0
  buffer_load_dwordx4 v19, s[12:15], s47 offen offset:0 lds
  buffer_load_dwordx4 v19, s[12:15], s47 offen offset:1024 lds
  buffer_load_dwordx4 v19, s[12:15], s47 offen offset:2048 lds
  s_add_u32 s47, s47, 98304
  s_add_u32 m0, s46, 12288
  s_nop 0
  buffer_load_dwordx4 v19, s[12:15], s47 offen offset:0 lds
  buffer_load_dwordx4 v19, s[12:15], s47 offen offset:1024 lds
  buffer_load_dwordx4 v19, s[12:15], s47 offen offset:2048 lds
  s_add_u32 s47, s47, 98304
  s_add_u32 s46, s46, 24576
  s_cmp_eq_u32 s46, s78
  s_cselect_b32 s49, 73728, 0
  s_sub_u32 s46, s46, s49
  s_cmp_eq_u32 s47, 1572864
  s_cselect_b32 s47, 0, s47
  s_cmp_lg_u32 s42, 0
  s_cbranch_scc1 L_n0_98
  s_waitcnt vmcnt(6)
  v_readfirstlane_b32 s48, v22
  s_nop 3
  s_cmp_lg_u32 s48, 0
  s_cbranch_scc1 L_rdypollx
L_rdypoll:
  buffer_load_dword v22, v10, s[32:35], 0 offen sc1
  s_waitcnt vmcnt(0)
  v_readfirstlane_b32 s48, v22
  s_nop 3
  s_cmp_eq_u32 s48, 0
  s_cbranch_scc1 L_rdypoll
L_rdypollx:
  s_lshl_b32 s48, s40, 9
  s_lshl_b32 s49, s41, 2
  s_add_u32 s49, s48, s49
  v_mov_b32 v22, s43
  v_mov_b32 v23, 384
  s_mov_b64 exec, 1
  buffer_store_dword v22, v23, s[36:39], s49 offen sc1
  s_mov_b64 exec, -1
L_n0_98:
  buffer_load_dwordx4 v[32:35], v20, s[16:19], s86 offen
  s_add_u32 s86, s86, 16384
  buffer_load_dwordx4 v[36:39], v20, s[16:19], s86 offen
  s_add_u32 s86, s86, 16384
  buffer_load_dwordx4 v[40:43], v20, s[16:19], s86 offen
  s_add_u32 s86, s86, 16384
  buffer_load_dwordx4 v[44:47], v20, s[16:19], s86 offen
  s_add_u32 s86, s86, 16384
  s_cmp_eq_u32 s86, 524288
  s_cselect_b32 s86, 0, s86
  buffer_load_dwordx4 v[48:51], v20, s[16:19], s86 offen
  s_add_u32 s86, s86, 16384
  buffer_load_dwordx4 v[52:55], v20, s[16:19], s86 offen
  s_add_u32 s86, s86, 16384
  buffer_load_dwordx4 v[56:59], v20, s[16:19], s86 offen
  s_add_u32 s86, s86, 16384
  buffer_load_dwordx4 v[60:63], v20, s[16:19], s86 offen
  s_add_u32 s86, s86, 16384
  s_cmp_eq_u32 s86, 524288
  s_cselect_b32 s86, 0, s86
  s_waitcnt vmcnt(14)
  s_barrier
  s_lshl_b32 s48, s41, 2
  s_add_u32 s48, s48, s42
  s_mul_i32 s48, s48, 2048
  s_add_u32 s48, s48, s3
  s_add_u32 s49, s48, 8388608
  buffer_load_dwordx4 v[16:19], v24, s[36:39], s49 offen
  s_lshl_b32 s48, s41, 2
  s_add_u32 s48, s48, s42
  s_mul_i32 s48, s48, 2048
  s_add_u32 s48, s48, s53
  s_add_u32 s49, s48, 4194304
  buffer_load_dwordx4 v[16:19], v24, s[36:39], s49 offen
  buffer_load_dwordx4 v[64:67], v20, s[16:19], s86 offen
  s_add_u32 s86, s86, 16384
  buffer_load_dwordx4 v[68:71], v20, s[16:19], s86 offen
  s_add_u32 s86, s86, 16384
  buffer_load_dwordx4 v[72:75], v20, s[16:19], s86 offen
  s_add_u32 s86, s86, 16384
  buffer_load_dwordx4 v[76:79], v20, s[16:19], s86 offen
  s_add_u32 s86, s86, 16384
  s_cmp_eq_u32 s86, 524288
  s_cselect_b32 s86, 0, s86
  buffer_load_dwordx4 v[80:83], v20, s[16:19], s86 offen
  s_add_u32 s86, s86, 16384
  buffer_load_dwordx4 v[84:87], v20, s[16:19], s86 offen
  s_add_u32 s86, s86, 16384
  buffer_load_dwordx4 v[88:91], v20, s[16:19], s86 offen
  s_add_u32 s86, s86, 16384
  buffer_load_dwordx4 v[92:95], v20, s[16:19], s86 offen
  s_add_u32 s86, s86, 16384
  s_cmp_eq_u32 s86, 524288
  s_cselect_b32 s86, 0, s86
  s_waitcnt vmcnt(18)
  s_barrier
  buffer_load_dwordx4 v[96:99], v20, s[16:19], s86 offen
  s_add_u32 s86, s86, 16384
  buffer_load_dwordx4 v[100:103], v20, s[16:19], s86 offen
  s_add_u32 s86, s86, 16384
  buffer_load_dwordx4 v[104:107], v20, s[16:19], s86 offen
  s_add_u32 s86, s86, 16384
  buffer_load_dwordx4 v[108:111], v20, s[16:19], s86 offen
  s_add_u32 s86, s86, 16384
  s_cmp_eq_u32 s86, 524288
  s_cselect_b32 s86, 0, s86
  buffer_load_dwordx4 v[112:115], v20, s[16:19], s86 offen
  s_add_u32 s86, s86, 16384
  buffer_load_dwordx4 v[116:119], v20, s[16:19], s86 offen
  s_add_u32 s86, s86, 16384
  buffer_load_dwordx4 v[120:123], v20, s[16:19], s86 offen
  s_add_u32 s86, s86, 16384
  buffer_load_dwordx4 v[124:127], v20, s[16:19], s86 offen
  s_add_u32 s86, s86, 16384
  s_cmp_eq_u32 s86, 524288
  s_cselect_b32 s86, 0, s86
  buffer_load_dwordx4 a[0:3], v20, s[16:19], s86 offen
  s_add_u32 s86, s86, 16384
  buffer_load_dwordx4 a[4:7], v20, s[16:19], s86 offen
  s_add_u32 s86, s86, 16384
  buffer_load_dwordx4 a[8:11], v20, s[16:19], s86 offen
  s_add_u32 s86, s86, 16384
  buffer_load_dwordx4 a[12:15], v20, s[16:19], s86 offen
  s_add_u32 s86, s86, 16384
  s_cmp_eq_u32 s86, 524288
  s_cselect_b32 s86, 0, s86
  s_barrier
  buffer_load_dwordx4 a[16:19], v20, s[16:19], s86 offen
  s_add_u32 s86, s86, 16384
  buffer_load_dwordx4 a[20:23], v20, s[16:19], s86 offen
  s_add_u32 s86, s86, 16384
  buffer_load_dwordx4 a[24:27], v20, s[16:19], s86 offen
  s_add_u32 s86, s86, 16384
  buffer_load_dwordx4 a[28:31], v20, s[16:19], s86 offen
  s_add_u32 s86, s86, 16384
  s_cmp_eq_u32 s86, 524288
  s_cselect_b32 s86, 0, s86
  buffer_load_dwordx4 a[32:35], v21, s[20:23], s87 offen
  s_add_u32 s87, s87, 28672
  buffer_load_dwordx4 a[36:39], v21, s[20:23], s87 offen
  s_add_u32 s87, s87, 28672
  buffer_load_dwordx4 a[40:43], v21, s[20:23], s87 offen
  s_add_u32 s87, s87, 28672
  buffer_load_dwordx4 a[44:47], v21, s[20:23], s87 offen
  s_add_u32 s87, s87, 28672
  s_cmp_eq_u32 s87, 1835008
  s_cselect_b32 s87, 0, s87
  buffer_load_dwordx4 a[48:51], v21, s[20:23], s87 offen
  s_add_u32 s87, s87, 28672
  buffer_load_dwordx4 a[52:55], v21, s[20:23], s87 offen
  s_add_u32 s87, s87, 28672
  buffer_load_dwordx4 a[56:59], v21, s[20:23], s87 offen
  s_add_u32 s87, s87, 28672
  buffer_load_dwordx4 a[60:63], v21, s[20:23], s87 offen
  s_add_u32 s87, s87, 28672
  s_cmp_eq_u32 s87, 1835008
  s_cselect_b32 s87, 0, s87
  s_waitcnt vmcnt(38)
  v_mov_b32 v29, 1
  ds_write_b128 v26, v[32:35] offset:0
  ds_write_b128 v26, v[36:39] offset:1024
  ds_write_b128 v26, v[40:43] offset:2048
  ds_write_b128 v26, v[44:47] offset:3072
  ds_write_b32 v25, v29
  s_waitcnt vmcnt(34)
  v_mov_b32 v29, 2
  ds_write_b128 v26, v[48:51] offset:16384
  ds_write_b128 v26, v[52:55] offset:17408
  ds_write_b128 v26, v[56:59] offset:18432
  ds_write_b128 v26, v[60:63] offset:19456
  ds_write_b32 v25, v29
  s_waitcnt vmcnt(28)
  v_mov_b32 v29, 3
  ds_write_b128 v26, v[64:67] offset:32768
  ds_write_b128 v26, v[68:71] offset:33792
  ds_write_b128 v26, v[72:75] offset:34816
  ds_write_b128 v26, v[76:79] offset:35840
  ds_write_b32 v25, v29
  s_waitcnt vmcnt(24)
  v_mov_b32 v29, 4
  ds_write_b128 v26, v[80:83] offset:49152
  ds_write_b128 v26, v[84:87] offset:50176
  ds_write_b128 v26, v[88:91] offset:51200
  ds_write_b128 v26, v[92:95] offset:52224
  ds_write_b32 v25, v29
  s_waitcnt vmcnt(20)
  v_mov_b32 v29, 5
  ds_write_b128 v27, v[96:99] offset:0
  ds_write_b128 v27, v[100:103] offset:1024
  ds_write_b128 v27, v[104:107] offset:2048
  ds_write_b128 v27, v[108:111] offset:3072
  ds_write_b32 v25, v29
  buffer_load_dwordx4 a[64:67], v21, s[20:23], s87 offen
  s_add_u32 s87, s87, 28672
  buffer_load_dwordx4 a[68:71], v21, s[20:23], s87 offen
  s_add_u32 s87, s87, 28672
  buffer_load_dwordx4 a[72:75], v21, s[20:23], s87 offen
  s_add_u32 s87, s87, 28672
  buffer_load_dwordx4 a[76:79], v21, s[20:23], s87 offen
  s_add_u32 s87, s87, 28672
  s_cmp_eq_u32 s87, 1835008
  s_cselect_b32 s87, 0, s87
  buffer_load_dwordx4 a[80:83], v21, s[20:23], s87 offen
  s_add_u32 s87, s87, 28672
  buffer_load_dwordx4 a[84:87], v21, s[20:23], s87 offen
  s_add_u32 s87, s87, 28672
  buffer_load_dwordx4 a[88:91], v21, s[20:23], s87 offen
  s_add_u32 s87, s87, 28672
  buffer_load_dwordx4 a[92:95], v21, s[20:23], s87 offen
  s_add_u32 s87, s87, 28672
  s_cmp_eq_u32 s87, 1835008
  s_cselect_b32 s87, 0, s87
  buffer_load_dwordx4 a[96:99], v21, s[20:23], s87 offen
  s_add_u32 s87, s87, 28672
  buffer_load_dwordx4 a[100:103], v21, s[20:23], s87 offen
  s_add_u32 s87, s87, 28672
  buffer_load_dwordx4 a[104:107], v21, s[20:23], s87 offen
  s_add_u32 s87, s87, 28672
  buffer_load_dwordx4 a[108:111], v21, s[20:23], s87 offen
  s_add_u32 s87, s87, 28672
  s_cmp_eq_u32 s87, 1835008
  s_cselect_b32 s87, 0, s87
  buffer_load_dwordx4 a[112:115], v21, s[20:23], s87 offen
  s_add_u32 s87, s87, 28672
  buffer_load_dwordx4 a[116:119], v21, s[20:23], s87 offen
  s_add_u32 s87, s87, 28672
  buffer_load_dwordx4 a[120:123], v21, s[20:23], s87 offen
  s_add_u32 s87, s87, 28672
  buffer_load_dwordx4 a[124:127], v21, s[20:23], s87 offen
  s_add_u32 s87, s87, 28672
  s_cmp_eq_u32 s87, 1835008
  s_cselect_b32 s87, 0, s87
  s_cmp_ge_u32 s90, 1
  s_cbranch_scc1 L_fr_99x
L_fr_99:
  ds_read_b32 v28, v25 offset:16
  s_waitcnt lgkmcnt(0)
  v_readfirstlane_b32 s90, v28
  s_nop 3
  s_cmp_ge_u32 s90, 1
  s_cbranch_scc1 L_fr_99x
  s_sleep 1
  s_branch L_fr_99
L_fr_99x:
  s_waitcnt vmcnt(32)
  v_mov_b32 v29, 6
  ds_write_b128 v26, v[112:115] offset:0
  ds_write_b128 v26, v[116:119] offset:1024
  ds_write_b128 v26, v[120:123] offset:2048
  ds_write_b128 v26, v[124:127] offset:3072
  ds_write_b32 v25, v29
  buffer_load_dwordx4 v[32:35], v21, s[20:23], s87 offen
  s_add_u32 s87, s87, 28672
  buffer_load_dwordx4 v[36:39], v21, s[20:23], s87 offen
  s_add_u32 s87, s87, 28672
  buffer_load_dwordx4 v[40:43], v21, s[20:23], s87 offen
  s_add_u32 s87, s87, 28672
  buffer_load_dwordx4 v[44:47], v21, s[20:23], s87 offen
  s_add_u32 s87, s87, 28672
  s_cmp_eq_u32 s87, 1835008
  s_cselect_b32 s87, 0, s87
  buffer_load_dwordx4 v[48:51], v21, s[20:23], s87 offen
  s_add_u32 s87, s87, 28672
  buffer_load_dwordx4 v[52:55], v21, s[20:23], s87 offen
  s_add_u32 s87, s87, 28672
  buffer_load_dwordx4 v[56:59], v21, s[20:23], s87 offen
  s_add_u32 s87, s87, 28672
  buffer_load_dwordx4 v[60:63], v21, s[20:23], s87 offen
  s_add_u32 s87, s87, 28672
  s_cmp_eq_u32 s87, 1835008
  s_cselect_b32 s87, 0, s87
  s_cmp_ge_u32 s90, 2
  s_cbranch_scc1 L_fr_100x
L_fr_100:
  ds_read_b32 v28, v25 offset:16
  s_waitcnt lgkmcnt(0)
  v_readfirstlane_b32 s90, v28
  s_nop 3
  s_cmp_ge_u32 s90, 2
  s_cbranch_scc1 L_fr_100x
  s_sleep 1
  s_branch L_fr_100
L_fr_100x:
  s_waitcnt vmcnt(36)
  v_mov_b32 v29, 7
  ds_write_b128 v26, a[0:3] offset:16384
  ds_write_b128 v26, a[4:7] offset:17408
  ds_write_b128 v26, a[8:11] offset:18432
  ds_write_b128 v26, a[12:15] offset:19456
  ds_write_b32 v25, v29
  buffer_load_dwordx4 v[64:67], v21, s[20:23], s87 offen
  s_add_u32 s87, s87, 28672
  buffer_load_dwordx4 v[68:71], v21, s[20:23], s87 offen
  s_add_u32 s87, s87, 28672
  buffer_load_dwordx4 v[72:75], v21, s[20:23], s87 offen
  s_add_u32 s87, s87, 28672
  buffer_load_dwordx4 v[76:79], v21, s[20:23], s87 offen
  s_add_u32 s87, s87, 28672
  s_cmp_eq_u32 s87, 1835008
  s_cselect_b32 s87, 0, s87
  buffer_load_dwordx4 v[80:83], v21, s[20:23], s87 offen
  s_add_u32 s87, s87, 28672
  buffer_load_dwordx4 v[84:87], v21, s[20:23], s87 offen
  s_add_u32 s87, s87, 28672
  buffer_load_dwordx4 v[88:91], v21, s[20:23], s87 offen
  s_add_u32 s87, s87, 28672
  buffer_load_dwordx4 v[92:95], v21, s[20:23], s87 offen
  s_add_u32 s87, s87, 28672
  s_cmp_eq_u32 s87, 1835008
  s_cselect_b32 s87, 0, s87
  s_cmp_ge_u32 s90, 3
  s_cbranch_scc1 L_fr_101x
L_fr_101:
  ds_read_b32 v28, v25 offset:16
  s_waitcnt lgkmcnt(0)
  v_readfirstlane_b32 s90, v28
  s_nop 3
  s_cmp_ge_u32 s90, 3
  s_cbranch_scc1 L_fr_101x
  s_sleep 1
  s_branch L_fr_101
L_fr_101x:
  s_waitcnt vmcnt(40)
  v_mov_b32 v29, 8
  ds_write_b128 v26, a[16:19] offset:32768
  ds_write_b128 v26, a[20:23] offset:33792
  ds_write_b128 v26, a[24:27] offset:34816
  ds_write_b128 v26, a[28:31] offset:35840
  ds_write_b32 v25, v29
  buffer_load_dwordx4 v[96:99], v21, s[20:23], s87 offen
  s_add_u32 s87, s87, 28672
  buffer_load_dwordx4 v[100:103], v21, s[20:23], s87 offen
  s_add_u32 s87, s87, 28672
  buffer_load_dwordx4 v[104:107], v21, s[20:23], s87 offen
  s_add_u32 s87, s87, 28672
  buffer_load_dwordx4 v[108:111], v21, s[20:23], s87 offen
  s_add_u32 s87, s87, 28672
  s_cmp_eq_u32 s87, 1835008
  s_cselect_b32 s87, 0, s87
  buffer_load_dwordx4 v[112:115], v21, s[20:23], s87 offen
  s_add_u32 s87, s87, 28672
  buffer_load_dwordx4 v[116:119], v21, s[20:23], s87 offen
  s_add_u32 s87, s87, 28672
  buffer_load_dwordx4 v[120:123], v21, s[20:23], s87 offen
  s_add_u32 s87, s87, 28672
  buffer_load_dwordx4 v[124:127], v21, s[20:23], s87 offen
  s_add_u32 s87, s87, 28672
  s_cmp_eq_u32 s87, 1835008
  s_cselect_b32 s87, 0, s87
  s_cmp_ge_u32 s90, 4
  s_cbranch_scc1 L_fr_102x
L_fr_102:
  ds_read_b32 v28, v25 offset:16
  s_waitcnt lgkmcnt(0)
  v_readfirstlane_b32 s90, v28
  s_nop 3
  s_cmp_ge_u32 s90, 4
  s_cbranch_scc1 L_fr_102x
  s_sleep 1
  s_branch L_fr_102
L_fr_102x:
  s_waitcnt vmcnt(44)
  v_mov_b32 v29, 9
  ds_write_b128 v26, a[32:35] offset:49152
  ds_write_b128 v26, a[36:39] offset:50176
  ds_write_b128 v26, a[40:43] offset:51200
  ds_write_b128 v26, a[44:47] offset:52224
  ds_write_b32 v25, v29
  buffer_load_dwordx4 a[0:3], v21, s[20:23], s87 offen
  s_add_u32 s87, s87, 28672
  buffer_load_dwordx4 a[4:7], v21, s[20:23], s87 offen
  s_add_u32 s87, s87, 28672
  buffer_load_dwordx4 a[8:11], v21, s[20:23], s87 offen
  s_add_u32 s87, s87, 28672
  buffer_load_dwordx4 a[12:15], v21, s[20:23], s87 offen
  s_add_u32 s87, s87, 28672
  s_cmp_eq_u32 s87, 1835008
  s_cselect_b32 s87, 0, s87
  buffer_load_dwordx4 a[16:19], v21, s[20:23], s87 offen
  s_add_u32 s87, s87, 28672
  buffer_load_dwordx4 a[20:23], v21, s[20:23], s87 offen
  s_add_u32 s87, s87, 28672
  buffer_load_dwordx4 a[24:27], v21, s[20:23], s87 offen
  s_add_u32 s87, s87, 28672
  buffer_load_dwordx4 a[28:31], v21, s[20:23], s87 offen
  s_add_u32 s87, s87, 28672
  s_cmp_eq_u32 s87, 1835008
  s_cselect_b32 s87, 0, s87
  s_cmp_ge_u32 s90, 5
  s_cbranch_scc1 L_fr_103x
L_fr_103:
  ds_read_b32 v28, v25 offset:16
  s_waitcnt lgkmcnt(0)
  v_readfirstlane_b32 s90, v28
  s_nop 3
  s_cmp_ge_u32 s90, 5
  s_cbranch_scc1 L_fr_103x
  s_sleep 1
  s_branch L_fr_103
L_fr_103x:
  s_waitcnt vmcnt(48)
  v_mov_b32 v29, 10
  ds_write_b128 v27, a[48:51] offset:0
  ds_write_b128 v27, a[52:55] offset:1024
  ds_write_b128 v27, a[56:59] offset:2048
  ds_write_b128 v27, a[60:63] offset:3072
  ds_write_b32 v25, v29
  buffer_load_dwordx4 a[32:35], v21, s[20:23], s87 offen
  s_add_u32 s87, s87, 28672
  buffer_load_dwordx4 a[36:39], v21, s[20:23], s87 offen
  s_add_u32 s87, s87, 28672
  buffer_load_dwordx4 a[40:43], v21, s[20:23], s87 offen
  s_add_u32 s87, s87, 28672
  buffer_load_dwordx4 a[44:47], v21, s[20:23], s87 offen
  s_add_u32 s87, s87, 28672
  s_cmp_eq_u32 s87, 1835008
  s_cselect_b32 s87, 0, s87
  buffer_load_dwordx4 a[48:51], v21, s[20:23], s87 offen
  s_add_u32 s87, s87, 28672
  buffer_load_dwordx4 a[52:55], v21, s[20:23], s87 offen
  s_add_u32 s87, s87, 28672
  buffer_load_dwordx4 a[56:59], v21, s[20:23], s87 offen
  s_add_u32 s87, s87, 28672
  buffer_load_dwordx4 a[60:63], v21, s[20:23], s87 offen
  s_add_u32 s87, s87, 28672
  s_cmp_eq_u32 s87, 1835008
  s_cselect_b32 s87, 0, s87
  s_cmp_ge_u32 s90, 6
  s_cbranch_scc1 L_fr_104x
L_fr_104:
  ds_read_b32 v28, v25 offset:16
  s_waitcnt lgkmcnt(0)
  v_readfirstlane_b32 s90, v28
  s_nop 3
  s_cmp_ge_u32 s90, 6
  s_cbranch_scc1 L_fr_104x
  s_sleep 1
  s_branch L_fr_104
L_fr_104x:
  s_waitcnt vmcnt(52)
  v_mov_b32 v29, 11
  ds_write_b128 v26, a[64:67] offset:0
  ds_write_b128 v26, a[68:71] offset:1024
  ds_write_b128 v26, a[72:75] offset:2048
  ds_write_b128 v26, a[76:79] offset:3072
  ds_write_b32 v25, v29
  buffer_load_dwordx4 a[64:67], v14, s[24:27], s88 offen
  s_add_u32 s88, s88, 8192
  buffer_load_dwordx4 a[68:71], v14, s[24:27], s88 offen
  s_add_u32 s88, s88, 8192
  buffer_load_dwordx4 a[72:75], v14, s[24:27], s88 offen
  s_add_u32 s88, s88, 8192
  buffer_load_dwordx4 a[76:79], v14, s[24:27], s88 offen
  s_add_u32 s88, s88, 8192
  s_cmp_eq_u32 s88, s89
  s_cselect_b32 s48, 458752, 0
  s_sub_u32 s88, s88, s48
  s_cmp_ge_u32 s90, 7
  s_cbranch_scc1 L_fr_105x
L_fr_105:
  ds_read_b32 v28, v25 offset:16
  s_waitcnt lgkmcnt(0)
  v_readfirstlane_b32 s90, v28
  s_nop 3
  s_cmp_ge_u32 s90, 7
  s_cbranch_scc1 L_fr_105x
  s_sleep 1
  s_branch L_fr_105
L_fr_105x:
  s_waitcnt vmcnt(52)
  v_mov_b32 v29, 12
  ds_write_b128 v26, a[80:83] offset:16384
  ds_write_b128 v26, a[84:87] offset:17408
  ds_write_b128 v26, a[88:91] offset:18432
  ds_write_b128 v26, a[92:95] offset:19456
  ds_write_b32 v25, v29
  buffer_load_dwordx4 a[80:83], v14, s[24:27], s88 offen
  s_add_u32 s88, s88, 8192
  buffer_load_dwordx4 a[84:87], v14, s[24:27], s88 offen
  s_add_u32 s88, s88, 8192
  buffer_load_dwordx4 a[88:91], v14, s[24:27], s88 offen
  s_add_u32 s88, s88, 8192
  buffer_load_dwordx4 a[92:95], v14, s[24:27], s88 offen
  s_add_u32 s88, s88, 8192
  s_cmp_eq_u32 s88, s89
  s_cselect_b32 s48, 458752, 0
  s_sub_u32 s88, s88, s48
  s_cmp_ge_u32 s90, 8
  s_cbranch_scc1 L_fr_106x
L_fr_106:
  ds_read_b32 v28, v25 offset:16
  s_waitcnt lgkmcnt(0)
  v_readfirstlane_b32 s90, v28
  s_nop 3
  s_cmp_ge_u32 s90, 8
  s_cbranch_scc1 L_fr_106x
  s_sleep 1
  s_branch L_fr_106
L_fr_106x:
  s_waitcnt vmcnt(52)
  v_mov_b32 v29, 13
  ds_write_b128 v26, a[96:99] offset:32768
  ds_write_b128 v26, a[100:103] offset:33792
  ds_write_b128 v26, a[104:107] offset:34816
  ds_write_b128 v26, a[108:111] offset:35840
  ds_write_b32 v25, v29
  buffer_load_dwordx4 a[96:99], v14, s[24:27], s88 offen
  s_add_u32 s88, s88, 8192
  buffer_load_dwordx4 a[100:103], v14, s[24:27], s88 offen
  s_add_u32 s88, s88, 8192
  buffer_load_dwordx4 a[104:107], v14, s[24:27], s88 offen
  s_add_u32 s88, s88, 8192
  buffer_load_dwordx4 a[108:111], v14, s[24:27], s88 offen
  s_add_u32 s88, s88, 8192
  s_cmp_eq_u32 s88, s89
  s_cselect_b32 s48, 458752, 0
  s_sub_u32 s88, s88, s48
  s_cmp_ge_u32 s90, 9
  s_cbranch_scc1 L_fr_107x
L_fr_107:
  ds_read_b32 v28, v25 offset:16
  s_waitcnt lgkmcnt(0)
  v_readfirstlane_b32 s90, v28
  s_nop 3
  s_cmp_ge_u32 s90, 9
  s_cbranch_scc1 L_fr_107x
  s_sleep 1
  s_branch L_fr_107
L_fr_107x:
  s_waitcnt vmcnt(52)
  v_mov_b32 v29, 14
  ds_write_b128 v26, a[112:115] offset:49152
  ds_write_b128 v26, a[116:119] offset:50176
  ds_write_b128 v26, a[120:123] offset:51200
  ds_write_b128 v26, a[124:127] offset:52224
  ds_write_b32 v25, v29
  buffer_load_dwordx4 a[112:115], v14, s[24:27], s88 offen
  s_add_u32 s88, s88, 8192
  buffer_load_dwordx4 a[116:119], v14, s[24:27], s88 offen
  s_add_u32 s88, s88, 8192
  buffer_load_dwordx4 a[120:123], v14, s[24:27], s88 offen
  s_add_u32 s88, s88, 8192
  buffer_load_dwordx4 a[124:127], v14, s[24:27], s88 offen
  s_add_u32 s88, s88, 8192
  s_cmp_eq_u32 s88, s89
  s_cselect_b32 s48, 458752, 0
  s_sub_u32 s88, s88, s48
  s_cmp_ge_u32 s90, 10
  s_cbranch_scc1 L_fr_108x
L_fr_108:
  ds_read_b32 v28, v25 offset:16
  s_waitcnt lgkmcnt(0)
  v_readfirstlane_b32 s90, v28
  s_nop 3
  s_cmp_ge_u32 s90, 10
  s_cbranch_scc1 L_fr_108x
  s_sleep 1
  s_branch L_fr_108
L_fr_108x:
  s_waitcnt vmcnt(52)
  v_mov_b32 v29, 15
  ds_write_b128 v27, v[32:35] offset:0
  ds_write_b128 v27, v[36:39] offset:1024
  ds_write_b128 v27, v[40:43] offset:2048
  ds_write_b128 v27, v[44:47] offset:3072
  ds_write_b32 v25, v29
  buffer_load_dwordx4 v[32:35], v14, s[24:27], s88 offen
  s_add_u32 s88, s88, 8192
  buffer_load_dwordx4 v[36:39], v14, s[24:27], s88 offen
  s_add_u32 s88, s88, 8192
  buffer_load_dwordx4 v[40:43], v14, s[24:27], s88 offen
  s_add_u32 s88, s88, 8192
  buffer_load_dwordx4 v[44:47], v14, s[24:27], s88 offen
  s_add_u32 s88, s88, 8192
  s_cmp_eq_u32 s88, s89
  s_cselect_b32 s48, 458752, 0
  s_sub_u32 s88, s88, s48
  s_cmp_ge_u32 s90, 11
  s_cbranch_scc1 L_fr_109x
L_fr_109:
  ds_read_b32 v28, v25 offset:16
  s_waitcnt lgkmcnt(0)
  v_readfirstlane_b32 s90, v28
  s_nop 3
  s_cmp_ge_u32 s90, 11
  s_cbranch_scc1 L_fr_109x
  s_sleep 1
  s_branch L_fr_109
L_fr_109x:
  s_waitcnt vmcnt(52)
  v_mov_b32 v29, 16
  ds_write_b128 v26, v[48:51] offset:0
  ds_write_b128 v26, v[52:55] offset:1024
  ds_write_b128 v26, v[56:59] offset:2048
  ds_write_b128 v26, v[60:63] offset:3072
  ds_write_b32 v25, v29
  buffer_load_dwordx4 v[48:51], v14, s[24:27], s88 offen
  s_add_u32 s88, s88, 8192
  buffer_load_dwordx4 v[52:55], v14, s[24:27], s88 offen
  s_add_u32 s88, s88, 8192
  buffer_load_dwordx4 v[56:59], v14, s[24:27], s88 offen
  s_add_u32 s88, s88, 8192
  buffer_load_dwordx4 v[60:63], v14, s[24:27], s88 offen
  s_add_u32 s88, s88, 8192
  s_cmp_eq_u32 s88, s89
  s_cselect_b32 s48, 458752, 0
  s_sub_u32 s88, s88, s48
  s_cmp_ge_u32 s90, 12
  s_cbranch_scc1 L_fr_110x
L_fr_110:
  ds_read_b32 v28, v25 offset:16
  s_waitcnt lgkmcnt(0)
  v_readfirstlane_b32 s90, v28
  s_nop 3
  s_cmp_ge_u32 s90, 12
  s_cbranch_scc1 L_fr_110x
  s_sleep 1
  s_branch L_fr_110
L_fr_110x:
  s_waitcnt vmcnt(52)
  v_mov_b32 v29, 17
  ds_write_b128 v26, v[64:67] offset:16384
  ds_write_b128 v26, v[68:71] offset:17408
  ds_write_b128 v26, v[72:75] offset:18432
  ds_write_b128 v26, v[76:79] offset:19456
  ds_write_b32 v25, v29
  buffer_load_dwordx4 v[64:67], v14, s[24:27], s88 offen
  s_add_u32 s88, s88, 8192
  buffer_load_dwordx4 v[68:71], v14, s[24:27], s88 offen
  s_add_u32 s88, s88, 8192
  buffer_load_dwordx4 v[72:75], v14, s[24:27], s88 offen
  s_add_u32 s88, s88, 8192
  buffer_load_dwordx4 v[76:79], v14, s[24:27], s88 offen
  s_add_u32 s88, s88, 8192
  s_cmp_eq_u32 s88, s89
  s_cselect_b32 s48, 458752, 0
  s_sub_u32 s88, s88, s48
  s_cmp_ge_u32 s90, 13
  s_cbranch_scc1 L_fr_111x
L_fr_111:
  ds_read_b32 v28, v25 offset:16
  s_waitcnt lgkmcnt(0)
  v_readfirstlane_b32 s90, v28
  s_nop 3
  s_cmp_ge_u32 s90, 13
  s_cbranch_scc1 L_fr_111x
  s_sleep 1
  s_branch L_fr_111
L_fr_111x:
  s_waitcnt vmcnt(52)
  v_mov_b32 v29, 18
  ds_write_b128 v26, v[80:83] offset:32768
  ds_write_b128 v26, v[84:87] offset:33792
  ds_write_b128 v26, v[88:91] offset:34816
  ds_write_b128 v26, v[92:95] offset:35840
  ds_write_b32 v25, v29
  buffer_load_dwordx4 v[80:83], v14, s[24:27], s88 offen
  s_add_u32 s88, s88, 8192
  buffer_load_dwordx4 v[84:87], v14, s[24:27], s88 offen
  s_add_u32 s88, s88, 8192
  buffer_load_dwordx4 v[88:91], v14, s[24:27], s88 offen
  s_add_u32 s88, s88, 8192
  buffer_load_dwordx4 v[92:95], v14, s[24:27], s88 offen
  s_add_u32 s88, s88, 8192
  s_cmp_eq_u32 s88, s89
  s_cselect_b32 s48, 458752, 0
  s_sub_u32 s88, s88, s48
  s_cmp_ge_u32 s90, 14
  s_cbranch_scc1 L_fr_112x
L_fr_112:
  ds_read_b32 v28, v25 offset:16
  s_waitcnt lgkmcnt(0)
  v_readfirstlane_b32 s90, v28
  s_nop 3
  s_cmp_ge_u32 s90, 14
  s_cbranch_scc1 L_fr_112x
  s_sleep 1
  s_branch L_fr_112
L_fr_112x:
  s_waitcnt vmcnt(52)
  v_mov_b32 v29, 19
  ds_write_b128 v26, v[96:99] offset:49152
  ds_write_b128 v26, v[100:103] offset:50176
  ds_write_b128 v26, v[104:107] offset:51200
  ds_write_b128 v26, v[108:111] offset:52224
  ds_write_b32 v25, v29
  buffer_load_dwordx4 v[96:99], v14, s[24:27], s88 offen
  s_add_u32 s88, s88, 8192
  buffer_load_dwordx4 v[100:103], v14, s[24:27], s88 offen
  s_add_u32 s88, s88, 8192
  buffer_load_dwordx4 v[104:107], v14, s[24:27], s88 offen
  s_add_u32 s88, s88, 8192
  buffer_load_dwordx4 v[108:111], v14, s[24:27], s88 offen
  s_add_u32 s88, s88, 8192
  s_cmp_eq_u32 s88, s89
  s_cselect_b32 s48, 458752, 0
  s_sub_u32 s88, s88, s48
  s_cmp_ge_u32 s90, 15
  s_cbranch_scc1 L_fr_113x
L_fr_113:
  ds_read_b32 v28, v25 offset:16
  s_waitcnt lgkmcnt(0)
  v_readfirstlane_b32 s90, v28
  s_nop 3
  s_cmp_ge_u32 s90, 15
  s_cbranch_scc1 L_fr_113x
  s_sleep 1
  s_branch L_fr_113
L_fr_113x:
  s_waitcnt vmcnt(52)
  v_mov_b32 v29, 20
  ds_write_b128 v27, v[112:115] offset:0
  ds_write_b128 v27, v[116:119] offset:1024
  ds_write_b128 v27, v[120:123] offset:2048
  ds_write_b128 v27, v[124:127] offset:3072
  ds_write_b32 v25, v29
  buffer_load_dwordx4 v[112:115], v14, s[24:27], s88 offen
  s_add_u32 s88, s88, 8192
  buffer_load_dwordx4 v[116:119], v14, s[24:27], s88 offen
  s_add_u32 s88, s88, 8192
  buffer_load_dwordx4 v[120:123], v14, s[24:27], s88 offen
  s_add_u32 s88, s88, 8192
  buffer_load_dwordx4 v[124:127], v14, s[24:27], s88 offen
  s_add_u32 s88, s88, 8192
  s_cmp_eq_u32 s88, s89
  s_cselect_b32 s48, 458752, 0
  s_sub_u32 s88, s88, s48
  s_cmp_ge_u32 s90, 16
  s_cbranch_scc1 L_fr_114x
L_fr_114:
  ds_read_b32 v28, v25 offset:16
  s_waitcnt lgkmcnt(0)
  v_readfirstlane_b32 s90, v28
  s_nop 3
  s_cmp_ge_u32 s90, 16
  s_cbranch_scc1 L_fr_114x
  s_sleep 1
  s_branch L_fr_114
L_fr_114x:
  s_waitcnt vmcnt(52)
  v_mov_b32 v29, 21
  ds_write_b128 v26, a[0:3] offset:0
  ds_write_b128 v26, a[4:7] offset:1024
  ds_write_b128 v26, a[8:11] offset:2048
  ds_write_b128 v26, a[12:15] offset:3072
  ds_write_b32 v25, v29
  buffer_load_dwordx4 a[0:3], v14, s[24:27], s88 offen
  s_add_u32 s88, s88, 8192
  buffer_load_dwordx4 a[4:7], v14, s[24:27], s88 offen
  s_add_u32 s88, s88, 8192
  buffer_load_dwordx4 a[8:11], v14, s[24:27], s88 offen
  s_add_u32 s88, s88, 8192
  buffer_load_dwordx4 a[12:15], v14, s[24:27], s88 offen
  s_add_u32 s88, s88, 8192
  s_cmp_eq_u32 s88, s89
  s_cselect_b32 s48, 458752, 0
  s_sub_u32 s88, s88, s48
  s_cmp_ge_u32 s90, 17
  s_cbranch_scc1 L_fr_115x
L_fr_115:
  ds_read_b32 v28, v25 offset:16
  s_waitcnt lgkmcnt(0)
  v_readfirstlane_b32 s90, v28
  s_nop 3
  s_cmp_ge_u32 s90, 17
  s_cbranch_scc1 L_fr_115x
  s_sleep 1
  s_branch L_fr_115
L_fr_115x:
  s_waitcnt vmcnt(52)
  v_mov_b32 v29, 22
  ds_write_b128 v26, a[16:19] offset:16384
  ds_write_b128 v26, a[20:23] offset:17408
  ds_write_b128 v26, a[24:27] offset:18432
  ds_write_b128 v26, a[28:31] offset:19456
  ds_write_b32 v25, v29
  buffer_load_dwordx4 a[16:19], v14, s[24:27], s88 offen
  s_add_u32 s88, s88, 8192
  buffer_load_dwordx4 a[20:23], v14, s[24:27], s88 offen
  s_add_u32 s88, s88, 8192
  buffer_load_dwordx4 a[24:27], v14, s[24:27], s88 offen
  s_add_u32 s88, s88, 8192
  buffer_load_dwordx4 a[28:31], v14, s[24:27], s88 offen
  s_add_u32 s88, s88, 8192
  s_cmp_eq_u32 s88, s89
  s_cselect_b32 s48, 458752, 0
  s_sub_u32 s88, s88, s48
  s_cmp_ge_u32 s90, 18
  s_cbranch_scc1 L_fr_116x
L_fr_116:
  ds_read_b32 v28, v25 offset:16
  s_waitcnt lgkmcnt(0)
  v_readfirstlane_b32 s90, v28
  s_nop 3
  s_cmp_ge_u32 s90, 18
  s_cbranch_scc1 L_fr_116x
  s_sleep 1
  s_branch L_fr_116
L_fr_116x:
  s_waitcnt vmcnt(52)
  v_mov_b32 v29, 23
  ds_write_b128 v26, a[32:35] offset:32768
  ds_write_b128 v26, a[36:39] offset:33792
  ds_write_b128 v26, a[40:43] offset:34816
  ds_write_b128 v26, a[44:47] offset:35840
  ds_write_b32 v25, v29
  buffer_load_dwordx4 a[32:35], v14, s[24:27], s88 offen
  s_add_u32 s88, s88, 8192
  buffer_load_dwordx4 a[36:39], v14, s[24:27], s88 offen
  s_add_u32 s88, s88, 8192
  buffer_load_dwordx4 a[40:43], v14, s[24:27], s88 offen
  s_add_u32 s88, s88, 8192
  buffer_load_dwordx4 a[44:47], v14, s[24:27], s88 offen
  s_add_u32 s88, s88, 8192
  s_cmp_eq_u32 s88, s89
  s_cselect_b32 s48, 458752, 0
  s_sub_u32 s88, s88, s48
  s_cmp_ge_u32 s90, 19
  s_cbranch_scc1 L_fr_117x
L_fr_117:
  ds_read_b32 v28, v25 offset:16
  s_waitcnt lgkmcnt(0)
  v_readfirstlane_b32 s90, v28
  s_nop 3
  s_cmp_ge_u32 s90, 19
  s_cbranch_scc1 L_fr_117x
  s_sleep 1
  s_branch L_fr_117
L_fr_117x:
  s_waitcnt vmcnt(52)
  v_mov_b32 v29, 24
  ds_write_b128 v26, a[48:51] offset:49152
  ds_write_b128 v26, a[52:55] offset:50176
  ds_write_b128 v26, a[56:59] offset:51200
  ds_write_b128 v26, a[60:63] offset:52224
  ds_write_b32 v25, v29
  buffer_load_dwordx4 a[48:51], v14, s[24:27], s88 offen
  s_add_u32 s88, s88, 8192
  buffer_load_dwordx4 a[52:55], v14, s[24:27], s88 offen
  s_add_u32 s88, s88, 8192
  buffer_load_dwordx4 a[56:59], v14, s[24:27], s88 offen
  s_add_u32 s88, s88, 8192
  buffer_load_dwordx4 a[60:63], v14, s[24:27], s88 offen
  s_add_u32 s88, s88, 8192
  s_cmp_eq_u32 s88, s89
  s_cselect_b32 s48, 458752, 0
  s_sub_u32 s88, s88, s48
  s_lshl_b32 s48, s41, 2
  s_add_u32 s48, s48, s42
  s_mul_i32 s48, s48, 5120
  s_add_u32 s48, s48, s3
  s_add_u32 s49, s48, 8454144
  buffer_load_dwordx4 v[16:19], v24, s[36:39], s49 offen
  s_add_u32 s49, s48, 8456192
  buffer_load_dwordx4 v[16:19], v24, s[36:39], s49 offen
  s_add_u32 s49, s48, 8458240
  buffer_load_dwordx4 v[16:19], v24, s[36:39], s49 offen
  s_cmp_ge_u32 s90, 20
  s_cbranch_scc1 L_fr_118x
L_fr_118:
  ds_read_b32 v28, v25 offset:16
  s_waitcnt lgkmcnt(0)
  v_readfirstlane_b32 s90, v28
  s_nop 3
  s_cmp_ge_u32 s90, 20
  s_cbranch_scc1 L_fr_118x
  s_sleep 1
  s_branch L_fr_118
L_fr_118x:
  s_waitcnt vmcnt(55)
  v_mov_b32 v29, 25
  ds_write_b128 v27, a[64:67] offset:0
  ds_write_b128 v27, a[68:71] offset:1024
  ds_write_b128 v27, a[72:75] offset:2048
  ds_write_b128 v27, a[76:79] offset:3072
  ds_write_b32 v25, v29
  s_cmp_ge_u32 s90, 21
  s_cbranch_scc1 L_fr_119x
L_fr_119:
  ds_read_b32 v28, v25 offset:16
  s_waitcnt lgkmcnt(0)
  v_readfirstlane_b32 s90, v28
  s_nop 3
  s_cmp_ge_u32 s90, 21
  s_cbranch_scc1 L_fr_119x
  s_sleep 1
  s_branch L_fr_119
L_fr_119x:
  s_waitcnt vmcnt(51)
  v_mov_b32 v29, 26
  ds_write_b128 v26, a[80:83] offset:0
  ds_write_b128 v26, a[84:87] offset:1024
  ds_write_b128 v26, a[88:91] offset:2048
  ds_write_b128 v26, a[92:95] offset:3072
  ds_write_b32 v25, v29
  s_cmp_ge_u32 s90, 22
  s_cbranch_scc1 L_fr_120x
L_fr_120:
  ds_read_b32 v28, v25 offset:16
  s_waitcnt lgkmcnt(0)
  v_readfirstlane_b32 s90, v28
  s_nop 3
  s_cmp_ge_u32 s90, 22
  s_cbranch_scc1 L_fr_120x
  s_sleep 1
  s_branch L_fr_120
L_fr_120x:
  s_waitcnt vmcnt(47)
  v_mov_b32 v29, 27
  ds_write_b128 v26, a[96:99] offset:16384
  ds_write_b128 v26, a[100:103] offset:17408
  ds_write_b128 v26, a[104:107] offset:18432
  ds_write_b128 v26, a[108:111] offset:19456
  ds_write_b32 v25, v29
  s_cmp_ge_u32 s90, 23
  s_cbranch_scc1 L_fr_121x
L_fr_121:
  ds_read_b32 v28, v25 offset:16
  s_waitcnt lgkmcnt(0)
  v_readfirstlane_b32 s90, v28
  s_nop 3
  s_cmp_ge_u32 s90, 23
  s_cbranch_scc1 L_fr_121x
  s_sleep 1
  s_branch L_fr_121
L_fr_121x:
  s_waitcnt vmcnt(43)
  v_mov_b32 v29, 28
  ds_write_b128 v26, a[112:115] offset:32768
  ds_write_b128 v26, a[116:119] offset:33792
  ds_write_b128 v26, a[120:123] offset:34816
  ds_write_b128 v26, a[124:127] offset:35840
  ds_write_b32 v25, v29
  s_cmp_ge_u32 s90, 24
  s_cbranch_scc1 L_fr_122x
L_fr_122:
  ds_read_b32 v28, v25 offset:16
  s_waitcnt lgkmcnt(0)
  v_readfirstlane_b32 s90, v28
  s_nop 3
  s_cmp_ge_u32 s90, 24
  s_cbranch_scc1 L_fr_122x
  s_sleep 1
  s_branch L_fr_122
L_fr_122x:
  s_waitcnt vmcnt(39)
  v_mov_b32 v29, 29
  ds_write_b128 v26, v[32:35] offset:49152
  ds_write_b128 v26, v[36:39] offset:50176
  ds_write_b128 v26, v[40:43] offset:51200
  ds_write_b128 v26, v[44:47] offset:52224
  ds_write_b32 v25, v29
  s_cmp_ge_u32 s90, 25
  s_cbranch_scc1 L_fr_123x
L_fr_123:
  ds_read_b32 v28, v25 offset:16
  s_waitcnt lgkmcnt(0)
  v_readfirstlane_b32 s90, v28
  s_nop 3
  s_cmp_ge_u32 s90, 25
  s_cbranch_scc1 L_fr_123x
  s_sleep 1
  s_branch L_fr_123
L_fr_123x:
  s_waitcnt vmcnt(35)
  v_mov_b32 v29, 30
  ds_write_b128 v27, v[48:51] offset:0
  ds_write_b128 v27, v[52:55] offset:1024
  ds_write_b128 v27, v[56:59] offset:2048
  ds_write_b128 v27, v[60:63] offset:3072
  ds_write_b32 v25, v29
  s_cmp_ge_u32 s90, 26
  s_cbranch_scc1 L_fr_124x
L_fr_124:
  ds_read_b32 v28, v25 offset:16
  s_waitcnt lgkmcnt(0)
  v_readfirstlane_b32 s90, v28
  s_nop 3
  s_cmp_ge_u32 s90, 26
  s_cbranch_scc1 L_fr_124x
  s_sleep 1
  s_branch L_fr_124
L_fr_124x:
  s_waitcnt vmcnt(31)
  v_mov_b32 v29, 31
  ds_write_b128 v26, v[64:67] offset:0
  ds_write_b128 v26, v[68:71] offset:1024
  ds_write_b128 v26, v[72:75] offset:2048
  ds_write_b128 v26, v[76:79] offset:3072
  ds_write_b32 v25, v29
  s_cmp_ge_u32 s90, 27
  s_cbranch_scc1 L_fr_125x
L_fr_125:
  ds_read_b32 v28, v25 offset:16
  s_waitcnt lgkmcnt(0)
  v_readfirstlane_b32 s90, v28
  s_nop 3
  s_cmp_ge_u32 s90, 27
  s_cbranch_scc1 L_fr_125x
  s_sleep 1
  s_branch L_fr_125
L_fr_125x:
  s_waitcnt vmcnt(27)
  v_mov_b32 v29, 32
  ds_write_b128 v26, v[80:83] offset:16384
  ds_write_b128 v26, v[84:87] offset:17408
  ds_write_b128 v26, v[88:91] offset:18432
  ds_write_b128 v26, v[92:95] offset:19456
  ds_write_b32 v25, v29
  s_cmp_ge_u32 s90, 28
  s_cbranch_scc1 L_fr_126x
L_fr_126:
  ds_read_b32 v28, v25 offset:16
  s_waitcnt lgkmcnt(0)
  v_readfirstlane_b32 s90, v28
  s_nop 3
  s_cmp_ge_u32 s90, 28
  s_cbranch_scc1 L_fr_126x
  s_sleep 1
  s_branch L_fr_126
L_fr_126x:
  s_waitcnt vmcnt(23)
  v_mov_b32 v29, 33
  ds_write_b128 v26, v[96:99] offset:32768
  ds_write_b128 v26, v[100:103] offset:33792
  ds_write_b128 v26, v[104:107] offset:34816
  ds_write_b128 v26, v[108:111] offset:35840
  ds_write_b32 v25, v29
  s_cmp_ge_u32 s90, 29
  s_cbranch_scc1 L_fr_127x
L_fr_127:
  ds_read_b32 v28, v25 offset:16
  s_waitcnt lgkmcnt(0)
  v_readfirstlane_b32 s90, v28
  s_nop 3
  s_cmp_ge_u32 s90, 29
  s_cbranch_scc1 L_fr_127x
  s_sleep 1
  s_branch L_fr_127
L_fr_127x:
  s_waitcnt vmcnt(19)
  v_mov_b32 v29, 34
  ds_write_b128 v26, v[112:115] offset:49152
  ds_write_b128 v26, v[116:119] offset:50176
  ds_write_b128 v26, v[120:123] offset:51200
  ds_write_b128 v26, v[124:127] offset:52224
  ds_write_b32 v25, v29
  s_cmp_ge_u32 s90, 30
  s_cbranch_scc1 L_fr_128x
L_fr_128:
  ds_read_b32 v28, v25 offset:16
  s_waitcnt lgkmcnt(0)
  v_readfirstlane_b32 s90, v28
  s_nop 3
  s_cmp_ge_u32 s90, 30
  s_cbranch_scc1 L_fr_128x
  s_sleep 1
  s_branch L_fr_128
L_fr_128x:
  s_waitcnt vmcnt(15)
  v_mov_b32 v29, 35
  ds_write_b128 v27, a[0:3] offset:0
  ds_write_b128 v27, a[4:7] offset:1024
  ds_write_b128 v27, a[8:11] offset:2048
  ds_write_b128 v27, a[12:15] offset:3072
  ds_write_b32 v25, v29
  s_cmp_ge_u32 s90, 31
  s_cbranch_scc1 L_fr_129x
L_fr_129:
  ds_read_b32 v28, v25 offset:16
  s_waitcnt lgkmcnt(0)
  v_readfirstlane_b32 s90, v28
  s_nop 3
  s_cmp_ge_u32 s90, 31
  s_cbranch_scc1 L_fr_129x
  s_sleep 1
  s_branch L_fr_129
L_fr_129x:
  s_waitcnt vmcnt(11)
  v_mov_b32 v29, 36
  ds_write_b128 v26, a[16:19] offset:0
  ds_write_b128 v26, a[20:23] offset:1024
  ds_write_b128 v26, a[24:27] offset:2048
  ds_write_b128 v26, a[28:31] offset:3072
  ds_write_b32 v25, v29
  s_cmp_ge_u32 s90, 32
  s_cbranch_scc1 L_fr_130x
L_fr_130:
  ds_read_b32 v28, v25 offset:16
  s_waitcnt lgkmcnt(0)
  v_readfirstlane_b32 s90, v28
  s_nop 3
  s_cmp_ge_u32 s90, 32
  s_cbranch_scc1 L_fr_130x
  s_sleep 1
  s_branch L_fr_130
L_fr_130x:
  s_waitcnt vmcnt(7)
  v_mov_b32 v29, 37
  ds_write_b128 v26, a[32:35] offset:16384
  ds_write_b128 v26, a[36:39] offset:17408
  ds_write_b128 v26, a[40:43] offset:18432
  ds_write_b128 v26, a[44:47] offset:19456
  ds_write_b32 v25, v29
  s_cmp_ge_u32 s90, 33
  s_cbranch_scc1 L_fr_131x
L_fr_131:
  ds_read_b32 v28, v25 offset:16
  s_waitcnt lgkmcnt(0)
  v_readfirstlane_b32 s90, v28
  s_nop 3
  s_cmp_ge_u32 s90, 33
  s_cbranch_scc1 L_fr_131x
  s_sleep 1
  s_branch L_fr_131
L_fr_131x:
  s_waitcnt vmcnt(3)
  v_mov_b32 v29, 38
  ds_write_b128 v26, a[48:51] offset:32768
  ds_write_b128 v26, a[52:55] offset:33792
  ds_write_b128 v26, a[56:59] offset:34816
  ds_write_b128 v26, a[60:63] offset:35840
  ds_write_b32 v25, v29
  s_endpgm
L_end:
  s_endpgm
.section .rodata,"a"
.p2align 6
.amdhsa_kernel sequential_preLN__sliding_local_dilated__dense_activation_silu__prompt_kernel
  .amdhsa_next_free_vgpr 256
  .amdhsa_next_free_sgpr 102
  .amdhsa_accum_offset 128
  .amdhsa_group_segment_fixed_size 0
  .amdhsa_kernarg_size 72
  .amdhsa_user_sgpr_count 2
  .amdhsa_user_sgpr_kernarg_segment_ptr 1
  .amdhsa_system_sgpr_workgroup_id_x 1
.end_amdhsa_kernel
```
